```python
import torch

def _softmax(x, axis=-1):
    return torch.softmax(x, dim=axis)
def _gelu(x):
    return torch.nn.functional.gelu(x, approximate="tanh")
def _silu(x):
    return torch.nn.functional.silu(x)
def _sigmoid(x):
    return torch.sigmoid(x)
def _layernorm(x, axis=-1, eps=1e-5):
    m = x.mean(dim=axis, keepdim=True)
    v = x.var(dim=axis, keepdim=True, unbiased=False)
    return (x - m) / torch.sqrt(v + eps)
def _scatter_add(tgt, idx, src, axis=0):
    return tgt.clone().index_add_(axis, idx, src)
def _segment_sum(src, seg, n):
    out = torch.zeros((n,) + src.shape[1:], dtype=src.dtype)
    return out.index_add_(0, seg, src)
def _pad(x, pw):
    flat = tuple(v for pair in reversed(pw) for v in pair)
    return torch.nn.functional.pad(x, flat)

kernel_name = 'recurrent_scan__mha_block__glu_gated_swiglu__prompt'

def setup_inputs():

    _w = (lambda a: (lambda t: t.to(torch.bfloat16) if t.is_floating_point() else t)(torch.as_tensor(a)))
    def _A_setup():
        B, S, D, H = 1, 2048, 576, 32
        return {
            "x": _w((lambda *s: torch.randn(*s, dtype=torch.bfloat16) * 0.05)(B, S, D)),
            "wqkv": _w((lambda *s: torch.randn(*s, dtype=torch.bfloat16) * 0.2)(D, 3 * D)),
            "wo": _w((lambda *s: torch.randn(*s, dtype=torch.bfloat16) * 0.2)(D, D)),
        }
    _A_in = _A_setup()

    def _B_setup():
        B, S, D, F = 1, 2048, 576, 4608
        return {
            "x": _w((lambda *s: torch.randn(*s, dtype=torch.bfloat16) * 0.05)(B, S, D)),
            "w1": _w((lambda *s: torch.randn(*s, dtype=torch.bfloat16) * 0.1)(D, F) * (2.0 / D) ** 0.5),
            "w3": _w((lambda *s: torch.randn(*s, dtype=torch.bfloat16) * 0.1)(D, F) * (2.0 / D) ** 0.5),
            "w2": _w((lambda *s: torch.randn(*s, dtype=torch.bfloat16) * 0.1)(F, D) * (2.0 / F) ** 0.5),
        }
    _B_in = _B_setup()

    return {
        "A_x": _A_in["x"],
        "A_wqkv": _A_in["wqkv"],
        "A_wo": _A_in["wo"],
        "B_x": _B_in["x"],
        "B_w1": _B_in["w1"],
        "B_w3": _B_in["w3"],
        "B_w2": _B_in["w2"],
    }

def reference(A_x, A_wqkv, A_wo, B_x, B_w1, B_w3, B_w2):
    def _A_ref(x, wqkv, wo):
        B, S, D = x.shape
        H = 32
        Dh = D // H
        qkv = (lambda x, *d: x.permute(*d))((x @ wqkv).reshape(B, S, 3, H, Dh), 2, 0, 3, 1, 4)
        q, k, v = qkv[0], qkv[1], qkv[2]
        scores = torch.einsum("bhqd,bhkd->bhqk", q, k) * (Dh ** -0.5)
        p = _softmax(scores, axis=-1)
        o = torch.einsum("bhqk,bhkd->bhqd", p, v)
        return (lambda x, *d: x.permute(*d))(o, 0, 2, 1, 3).reshape(B, S, D) @ wo

    def _B_ref(x, w1, w3, w2):
        gate = torch.einsum("bsd,df->bsf", x, w1)
        up = torch.einsum("bsd,df->bsf", x, w3)
        h = _silu(gate) * up
        out = torch.einsum("bsf,fd->bsd", h, w2)
        return out

    x = A_x
    xn = _layernorm(x, axis=-1)
    s = _A_ref(xn, A_wqkv, A_wo)
    g = _silu(_B_ref(xn, B_w1, B_w3, B_w2))
    return x + s * g
```

```asm
; @launch kernel=k1_proj_kernel grid=(256,1,1) block=(256,1,1) lds=147968
; @launch kernel=k2_attn_kernel grid=(256,1,1) block=(512,1,1) lds=161792
; @launch kernel=k3_out_kernel grid=(216,1,1) block=(384,1,1) lds=73728
.amdgcn_target "amdgcn-amd-amdhsa--gfx950"
.text
.globl k1_proj_kernel
.p2align 8
.type k1_proj_kernel,@function
k1_proj_kernel:

    s_cmp_ge_u32 s2, 256
    s_cbranch_scc1 K1_END
    s_load_dwordx4 s[4:7], s[0:1], 0
    s_load_dwordx4 s[8:11], s[0:1], 32
    s_load_dwordx2 s[12:13], s[0:1], 72
    v_lshrrev_b32 v1, 6, v0
    v_and_b32 v0, 63, v0
    v_readfirstlane_b32 s36, v1
    s_nop 3
    s_lshr_b32 s51, s2, 3
    s_lshl_b32 s51, s51, 2
    s_add_u32 s51, s51, s36
    s_getpc_b64 s[60:61]
K1_PC:
    s_add_u32 s60, s60, k1_proj_kernel-K1_PC
    s_addc_u32 s61, s61, 0-(((k1_proj_kernel-K1_PC)>>63)&1)
    s_mov_b32 s62, K1_CODE_END-k1_proj_kernel
    s_mov_b32 s63, 0x00020000
    s_mul_i32 s50, s51, 384
    v_min_u32 v16, 2, v0
    v_lshlrev_b32 v16, 7, v16
    buffer_load_dword a77, v16, s[60:63], s50 offen
    s_and_b32 s37, s2, 1
    s_lshl_b32 s37, s37, 3
    s_lshr_b32 s50, s2, 3
    s_and_b32 s50, s50, 7
    s_add_u32 s37, s37, s50
    s_lshr_b32 s38, s2, 1
    s_and_b32 s38, s38, 3
    s_lshl_b32 s38, s38, 2
    s_lshr_b32 s50, s2, 6
    s_add_u32 s38, s38, s50
    v_lshrrev_b32 v3, 3, v0
    v_lshrrev_b32 v12, 4, v0
    v_and_b32 v13, 7, v0
    v_xor_b32 v13, v12, v13
    v_lshlrev_b32 v13, 4, v13
    v_mov_b32 v14, 1152
    v_mad_u32_u24 v14, v3, v14, v13
    v_xor_b32 v15, 64, v14
    v_and_b32 v12, 1, v12
    v_lshlrev_b32 v12, 2, v12
    v_and_b32 v13, 7, v0
    v_xor_b32 v13, v12, v13
    v_lshlrev_b32 v4, 4, v13
    s_waitcnt lgkmcnt(0)
    s_mov_b32 s16, s4
    s_mov_b32 s17, s5
    s_mov_b32 s18, 2359296
    s_mov_b32 s19, 0x00020000
    s_lshl_b32 s55, s37, 7
    s_lshl_b32 s50, s36, 5
    s_add_u32 s58, s55, s50
    s_cmp_lt_u32 s38, 8
    s_cbranch_scc0 K1_NOTA
    s_mov_b32 s39, 1
    s_mov_b32 s40, 5
    s_mov_b32 s41, s38
    s_mul_i32 s42, s38, 5
    s_branch K1_SCHED
K1_NOTA:
    s_mov_b32 s40, 4
    s_sub_u32 s50, s38, 8
    s_lshl_b32 s42, s50, 2
    s_add_u32 s42, s42, 40
    s_cmp_lt_u32 s38, 11
    s_cbranch_scc0 K1_TYPED
    s_mov_b32 s39, 3
    s_mul_i32 s41, s50, 3
    s_add_u32 s41, s41, 8
    s_branch K1_SCHED
K1_TYPED:
    s_mov_b32 s39, 2
    s_sub_u32 s50, s38, 11
    s_lshl_b32 s41, s50, 1
    s_add_u32 s41, s41, 17
K1_SCHED:
    s_and_b32 s50, s37, 7
    s_mul_i32 s50, s50, 72
    s_mul_i32 s51, s36, 18
    s_add_u32 s50, s50, s51
    v_min_u32 v16, 17, v0
    v_add_u32 v16, s50, v16
    v_accvgpr_write_b32 a76, v16
    s_mov_b32 s63, 0x00020000
    s_mul_i32 s29, s58, 1152
    v_mov_b32 v26, v14
    v_mov_b32 v27, v15
K1_ARR0:
    s_lshl_b32 s50, s36, 12
    s_add_u32 m0, s50, 0
    s_add_u32 s44, s29, 0
    buffer_load_dwordx4 v26, s[16:19], s44 offen lds
    s_add_u32 m0, m0, 1024
    s_add_u32 s44, s44, 9216
    buffer_load_dwordx4 v27, s[16:19], s44 offen lds
    s_add_u32 m0, m0, 1024
    s_add_u32 s44, s44, 9216
    buffer_load_dwordx4 v26, s[16:19], s44 offen lds
    s_add_u32 m0, m0, 1024
    s_add_u32 s44, s44, 9216
    buffer_load_dwordx4 v27, s[16:19], s44 offen lds
    s_mov_b32 s51, 1
    s_mov_b32 s60, s6
    s_mov_b32 s61, s7
    s_mul_i32 s62, s51, 1990656
    v_accvgpr_read_b32 v24, a76
    s_lshl_b32 s59, s41, 7
    v_mul_u32_u24 v24, 3456, v24
    buffer_load_dword a77, v24, s[60:63], s59 offen
    s_lshl_b32 s50, s36, 12
    s_add_u32 m0, s50, 16384
    s_add_u32 s44, s29, 128
    buffer_load_dwordx4 v26, s[16:19], s44 offen lds
    s_add_u32 m0, m0, 1024
    s_add_u32 s44, s44, 9216
    buffer_load_dwordx4 v27, s[16:19], s44 offen lds
    s_add_u32 m0, m0, 1024
    s_add_u32 s44, s44, 9216
    buffer_load_dwordx4 v26, s[16:19], s44 offen lds
    s_add_u32 m0, m0, 1024
    s_add_u32 s44, s44, 9216
    buffer_load_dwordx4 v27, s[16:19], s44 offen lds
    s_mov_b32 s24, s12
    s_mov_b32 s25, s13
    s_mov_b32 s26, 7133184
    s_mov_b32 s27, 0x00020000
    s_add_u32 s32, s12, 7133184
    s_addc_u32 s33, s13, 0
    s_mov_b32 s34, 0
    s_mov_b32 s35, 0x00020000
    s_mov_b32 s23, 0x00020000
    s_mov_b32 s47, 0
    v_and_b32 v20, 31, v0
    v_lshrrev_b32 v21, 5, v0
    s_lshr_b32 s50, s58, 5
    s_mul_i32 s50, s50, 294912
    v_lshlrev_b32 v8, 4, v0
    v_add_u32 v8, s50, v8
    v_lshrrev_b32 v17, 2, v20
    v_mul_u32_u24 v9, 16512, v17
    v_and_b32 v17, 3, v20
    v_lshl_add_u32 v9, v17, 5, v9
    v_lshl_add_u32 v9, v21, 4, v9
    s_lshl_b32 s50, s58, 3
    v_add_u32 v9, s50, v9
    v_lshrrev_b32 v16, 2, v0
    v_and_b32 v16, 3, v16
    v_lshlrev_b32 v17, 3, v21
    v_add_u32 v17, v17, v16
    v_lshlrev_b32 v17, 7, v17
    v_lshrrev_b32 v18, 1, v16
    v_lshlrev_b32 v18, 6, v18
    v_add_u32 v17, v17, v18
    v_lshrrev_b32 v18, 4, v0
    v_and_b32 v18, 1, v18
    v_lshlrev_b32 v18, 5, v18
    v_add_u32 v17, v17, v18
    v_and_b32 v18, 3, v0
    v_lshlrev_b32 v18, 3, v18
    v_add_u32 v1, v17, v18
    v_xor_b32 v2, 64, v1
    v_lshrrev_b32 v16, 3, v20
    v_lshlrev_b32 v16, 10, v16
    v_and_b32 v17, 7, v20
    v_lshlrev_b32 v17, 7, v17
    v_add_u32 v16, v16, v17
    s_lshl_b32 s50, s36, 12
    v_add_u32 v16, s50, v16
    v_lshrrev_b32 v17, 1, v20
    v_and_b32 v17, 7, v17
    v_xor_b32 v17, v17, v21
    v_xor_b32 v18, 0, v17
    v_lshlrev_b32 v18, 4, v18
    v_add_u32 v12, v16, v18
    v_xor_b32 v18, 2, v17
    v_lshlrev_b32 v18, 4, v18
    v_add_u32 v13, v16, v18
    v_xor_b32 v18, 4, v17
    v_lshlrev_b32 v18, 4, v18
    v_add_u32 v14, v16, v18
    v_xor_b32 v18, 6, v17
    v_lshlrev_b32 v18, 4, v18
    v_add_u32 v15, v16, v18
    s_mov_b32 s54, 0x3f803f80
    v_mov_b32 v192, 0
    v_mov_b32 v193, 0
    v_mov_b32 v194, 0
    v_mov_b32 v195, 0
    v_mov_b32 v196, 0
    v_mov_b32 v197, 0
    v_mov_b32 v198, 0
    v_mov_b32 v199, 0
    s_lshl_b32 s50, s36, 12
    s_add_u32 m0, s50, 32768
    s_add_u32 s44, s29, 256
    buffer_load_dwordx4 v26, s[16:19], s44 offen lds
    s_add_u32 m0, m0, 1024
    s_add_u32 s44, s44, 9216
    buffer_load_dwordx4 v27, s[16:19], s44 offen lds
    s_add_u32 m0, m0, 1024
    s_add_u32 s44, s44, 9216
    buffer_load_dwordx4 v26, s[16:19], s44 offen lds
    s_add_u32 m0, m0, 1024
    s_add_u32 s44, s44, 9216
    buffer_load_dwordx4 v27, s[16:19], s44 offen lds
    s_waitcnt vmcnt(9)
    ds_read_b128 v[28:31], v12 offset:0
    ds_read_b128 v[32:35], v13 offset:0
    ds_read_b128 v[36:39], v14 offset:0
    ds_read_b128 v[40:43], v15 offset:0
    s_waitcnt lgkmcnt(0)
    s_lshl_b32 s50, s36, 12
    s_add_u32 m0, s50, 49152
    s_add_u32 s44, s29, 384
    buffer_load_dwordx4 v26, s[16:19], s44 offen lds
    s_add_u32 m0, m0, 1024
    s_add_u32 s44, s44, 9216
    buffer_load_dwordx4 v27, s[16:19], s44 offen lds
    s_add_u32 m0, m0, 1024
    s_add_u32 s44, s44, 9216
    buffer_load_dwordx4 v26, s[16:19], s44 offen lds
    s_add_u32 m0, m0, 1024
    s_add_u32 s44, s44, 9216
    buffer_load_dwordx4 v27, s[16:19], s44 offen lds
    s_waitcnt vmcnt(8)
    ds_read_b128 v[44:47], v12 offset:16384
    ds_read_b128 v[48:51], v13 offset:16384
    ds_read_b128 v[52:55], v14 offset:16384
    ds_read_b128 v[56:59], v15 offset:16384
    v_dot2_f32_bf16 v192, v28, s54, v192
    v_dot2_f32_bf16 v196, v28, v28, v196
    v_dot2_f32_bf16 v193, v29, s54, v193
    v_dot2_f32_bf16 v197, v29, v29, v197
    v_dot2_f32_bf16 v194, v30, s54, v194
    v_dot2_f32_bf16 v198, v30, v30, v198
    v_dot2_f32_bf16 v195, v31, s54, v195
    v_dot2_f32_bf16 v199, v31, v31, v199
    v_dot2_f32_bf16 v192, v32, s54, v192
    v_dot2_f32_bf16 v196, v32, v32, v196
    v_dot2_f32_bf16 v193, v33, s54, v193
    v_dot2_f32_bf16 v197, v33, v33, v197
    v_dot2_f32_bf16 v194, v34, s54, v194
    v_dot2_f32_bf16 v198, v34, v34, v198
    v_dot2_f32_bf16 v195, v35, s54, v195
    v_dot2_f32_bf16 v199, v35, v35, v199
    v_dot2_f32_bf16 v192, v36, s54, v192
    v_dot2_f32_bf16 v196, v36, v36, v196
    v_dot2_f32_bf16 v193, v37, s54, v193
    v_dot2_f32_bf16 v197, v37, v37, v197
    v_dot2_f32_bf16 v194, v38, s54, v194
    v_dot2_f32_bf16 v198, v38, v38, v198
    v_dot2_f32_bf16 v195, v39, s54, v195
    v_dot2_f32_bf16 v199, v39, v39, v199
    v_dot2_f32_bf16 v192, v40, s54, v192
    v_dot2_f32_bf16 v196, v40, v40, v196
    v_dot2_f32_bf16 v193, v41, s54, v193
    v_dot2_f32_bf16 v197, v41, v41, v197
    v_dot2_f32_bf16 v194, v42, s54, v194
    v_dot2_f32_bf16 v198, v42, v42, v198
    v_dot2_f32_bf16 v195, v43, s54, v195
    v_dot2_f32_bf16 v199, v43, v43, v199
    s_waitcnt lgkmcnt(0)
    s_lshl_b32 s50, s36, 12
    s_add_u32 m0, s50, 65536
    s_add_u32 s44, s29, 512
    buffer_load_dwordx4 v26, s[16:19], s44 offen lds
    s_add_u32 m0, m0, 1024
    s_add_u32 s44, s44, 9216
    buffer_load_dwordx4 v27, s[16:19], s44 offen lds
    s_add_u32 m0, m0, 1024
    s_add_u32 s44, s44, 9216
    buffer_load_dwordx4 v26, s[16:19], s44 offen lds
    s_add_u32 m0, m0, 1024
    s_add_u32 s44, s44, 9216
    buffer_load_dwordx4 v27, s[16:19], s44 offen lds
    s_waitcnt vmcnt(8)
    ds_read_b128 v[60:63], v12 offset:32768
    ds_read_b128 v[64:67], v13 offset:32768
    ds_read_b128 v[68:71], v14 offset:32768
    ds_read_b128 v[72:75], v15 offset:32768
    v_dot2_f32_bf16 v192, v44, s54, v192
    v_dot2_f32_bf16 v196, v44, v44, v196
    v_dot2_f32_bf16 v193, v45, s54, v193
    v_dot2_f32_bf16 v197, v45, v45, v197
    v_dot2_f32_bf16 v194, v46, s54, v194
    v_dot2_f32_bf16 v198, v46, v46, v198
    v_dot2_f32_bf16 v195, v47, s54, v195
    v_dot2_f32_bf16 v199, v47, v47, v199
    v_dot2_f32_bf16 v192, v48, s54, v192
    v_dot2_f32_bf16 v196, v48, v48, v196
    v_dot2_f32_bf16 v193, v49, s54, v193
    v_dot2_f32_bf16 v197, v49, v49, v197
    v_dot2_f32_bf16 v194, v50, s54, v194
    v_dot2_f32_bf16 v198, v50, v50, v198
    v_dot2_f32_bf16 v195, v51, s54, v195
    v_dot2_f32_bf16 v199, v51, v51, v199
    v_dot2_f32_bf16 v192, v52, s54, v192
    v_dot2_f32_bf16 v196, v52, v52, v196
    v_dot2_f32_bf16 v193, v53, s54, v193
    v_dot2_f32_bf16 v197, v53, v53, v197
    v_dot2_f32_bf16 v194, v54, s54, v194
    v_dot2_f32_bf16 v198, v54, v54, v198
    v_dot2_f32_bf16 v195, v55, s54, v195
    v_dot2_f32_bf16 v199, v55, v55, v199
    v_dot2_f32_bf16 v192, v56, s54, v192
    v_dot2_f32_bf16 v196, v56, v56, v196
    v_dot2_f32_bf16 v193, v57, s54, v193
    v_dot2_f32_bf16 v197, v57, v57, v197
    v_dot2_f32_bf16 v194, v58, s54, v194
    v_dot2_f32_bf16 v198, v58, v58, v198
    v_dot2_f32_bf16 v195, v59, s54, v195
    v_dot2_f32_bf16 v199, v59, v59, v199
    s_waitcnt lgkmcnt(0)
    s_lshl_b32 s50, s36, 12
    s_add_u32 m0, s50, 81920
    s_add_u32 s44, s29, 640
    buffer_load_dwordx4 v26, s[16:19], s44 offen lds
    s_add_u32 m0, m0, 1024
    s_add_u32 s44, s44, 9216
    buffer_load_dwordx4 v27, s[16:19], s44 offen lds
    s_add_u32 m0, m0, 1024
    s_add_u32 s44, s44, 9216
    buffer_load_dwordx4 v26, s[16:19], s44 offen lds
    s_add_u32 m0, m0, 1024
    s_add_u32 s44, s44, 9216
    buffer_load_dwordx4 v27, s[16:19], s44 offen lds
    s_waitcnt vmcnt(8)
    ds_read_b128 v[76:79], v12 offset:49152
    ds_read_b128 v[80:83], v13 offset:49152
    ds_read_b128 v[84:87], v14 offset:49152
    ds_read_b128 v[88:91], v15 offset:49152
    v_dot2_f32_bf16 v192, v60, s54, v192
    v_dot2_f32_bf16 v196, v60, v60, v196
    v_dot2_f32_bf16 v193, v61, s54, v193
    v_dot2_f32_bf16 v197, v61, v61, v197
    v_dot2_f32_bf16 v194, v62, s54, v194
    v_dot2_f32_bf16 v198, v62, v62, v198
    v_dot2_f32_bf16 v195, v63, s54, v195
    v_dot2_f32_bf16 v199, v63, v63, v199
    v_dot2_f32_bf16 v192, v64, s54, v192
    v_dot2_f32_bf16 v196, v64, v64, v196
    v_dot2_f32_bf16 v193, v65, s54, v193
    v_dot2_f32_bf16 v197, v65, v65, v197
    v_dot2_f32_bf16 v194, v66, s54, v194
    v_dot2_f32_bf16 v198, v66, v66, v198
    v_dot2_f32_bf16 v195, v67, s54, v195
    v_dot2_f32_bf16 v199, v67, v67, v199
    v_dot2_f32_bf16 v192, v68, s54, v192
    v_dot2_f32_bf16 v196, v68, v68, v196
    v_dot2_f32_bf16 v193, v69, s54, v193
    v_dot2_f32_bf16 v197, v69, v69, v197
    v_dot2_f32_bf16 v194, v70, s54, v194
    v_dot2_f32_bf16 v198, v70, v70, v198
    v_dot2_f32_bf16 v195, v71, s54, v195
    v_dot2_f32_bf16 v199, v71, v71, v199
    v_dot2_f32_bf16 v192, v72, s54, v192
    v_dot2_f32_bf16 v196, v72, v72, v196
    v_dot2_f32_bf16 v193, v73, s54, v193
    v_dot2_f32_bf16 v197, v73, v73, v197
    v_dot2_f32_bf16 v194, v74, s54, v194
    v_dot2_f32_bf16 v198, v74, v74, v198
    v_dot2_f32_bf16 v195, v75, s54, v195
    v_dot2_f32_bf16 v199, v75, v75, v199
    s_waitcnt lgkmcnt(0)
    s_lshl_b32 s50, s36, 12
    s_add_u32 m0, s50, 98304
    s_add_u32 s44, s29, 768
    buffer_load_dwordx4 v26, s[16:19], s44 offen lds
    s_add_u32 m0, m0, 1024
    s_add_u32 s44, s44, 9216
    buffer_load_dwordx4 v27, s[16:19], s44 offen lds
    s_add_u32 m0, m0, 1024
    s_add_u32 s44, s44, 9216
    buffer_load_dwordx4 v26, s[16:19], s44 offen lds
    s_add_u32 m0, m0, 1024
    s_add_u32 s44, s44, 9216
    buffer_load_dwordx4 v27, s[16:19], s44 offen lds
    s_waitcnt vmcnt(8)
    v_add_u32 v12, 0x10000, v12
    v_add_u32 v13, 0x10000, v13
    v_add_u32 v14, 0x10000, v14
    v_add_u32 v15, 0x10000, v15
    ds_read_b128 v[92:95], v12 offset:0
    ds_read_b128 v[96:99], v13 offset:0
    ds_read_b128 v[100:103], v14 offset:0
    ds_read_b128 v[104:107], v15 offset:0
    v_dot2_f32_bf16 v192, v76, s54, v192
    v_dot2_f32_bf16 v196, v76, v76, v196
    v_dot2_f32_bf16 v193, v77, s54, v193
    v_dot2_f32_bf16 v197, v77, v77, v197
    v_dot2_f32_bf16 v194, v78, s54, v194
    v_dot2_f32_bf16 v198, v78, v78, v198
    v_dot2_f32_bf16 v195, v79, s54, v195
    v_dot2_f32_bf16 v199, v79, v79, v199
    v_dot2_f32_bf16 v192, v80, s54, v192
    v_dot2_f32_bf16 v196, v80, v80, v196
    v_dot2_f32_bf16 v193, v81, s54, v193
    v_dot2_f32_bf16 v197, v81, v81, v197
    v_dot2_f32_bf16 v194, v82, s54, v194
    v_dot2_f32_bf16 v198, v82, v82, v198
    v_dot2_f32_bf16 v195, v83, s54, v195
    v_dot2_f32_bf16 v199, v83, v83, v199
    v_dot2_f32_bf16 v192, v84, s54, v192
    v_dot2_f32_bf16 v196, v84, v84, v196
    v_dot2_f32_bf16 v193, v85, s54, v193
    v_dot2_f32_bf16 v197, v85, v85, v197
    v_dot2_f32_bf16 v194, v86, s54, v194
    v_dot2_f32_bf16 v198, v86, v86, v198
    v_dot2_f32_bf16 v195, v87, s54, v195
    v_dot2_f32_bf16 v199, v87, v87, v199
    v_dot2_f32_bf16 v192, v88, s54, v192
    v_dot2_f32_bf16 v196, v88, v88, v196
    v_dot2_f32_bf16 v193, v89, s54, v193
    v_dot2_f32_bf16 v197, v89, v89, v197
    v_dot2_f32_bf16 v194, v90, s54, v194
    v_dot2_f32_bf16 v198, v90, v90, v198
    v_dot2_f32_bf16 v195, v91, s54, v195
    v_dot2_f32_bf16 v199, v91, v91, v199
    s_waitcnt lgkmcnt(0)
    s_barrier
    s_lshl_b32 s50, s36, 12
    s_add_u32 m0, s50, 114688
    s_add_u32 s44, s29, 896
    buffer_load_dwordx4 v26, s[16:19], s44 offen lds
    s_add_u32 m0, m0, 1024
    s_add_u32 s44, s44, 9216
    buffer_load_dwordx4 v27, s[16:19], s44 offen lds
    s_add_u32 m0, m0, 1024
    s_add_u32 s44, s44, 9216
    buffer_load_dwordx4 v26, s[16:19], s44 offen lds
    s_add_u32 m0, m0, 1024
    s_add_u32 s44, s44, 9216
    buffer_load_dwordx4 v27, s[16:19], s44 offen lds
    s_waitcnt vmcnt(8)
    ds_read_b128 v[108:111], v12 offset:16384
    ds_read_b128 v[112:115], v13 offset:16384
    ds_read_b128 v[116:119], v14 offset:16384
    ds_read_b128 v[120:123], v15 offset:16384
    v_dot2_f32_bf16 v192, v92, s54, v192
    v_dot2_f32_bf16 v196, v92, v92, v196
    v_dot2_f32_bf16 v193, v93, s54, v193
    v_dot2_f32_bf16 v197, v93, v93, v197
    v_dot2_f32_bf16 v194, v94, s54, v194
    v_dot2_f32_bf16 v198, v94, v94, v198
    v_dot2_f32_bf16 v195, v95, s54, v195
    v_dot2_f32_bf16 v199, v95, v95, v199
    v_dot2_f32_bf16 v192, v96, s54, v192
    v_dot2_f32_bf16 v196, v96, v96, v196
    v_dot2_f32_bf16 v193, v97, s54, v193
    v_dot2_f32_bf16 v197, v97, v97, v197
    v_dot2_f32_bf16 v194, v98, s54, v194
    v_dot2_f32_bf16 v198, v98, v98, v198
    v_dot2_f32_bf16 v195, v99, s54, v195
    v_dot2_f32_bf16 v199, v99, v99, v199
    v_dot2_f32_bf16 v192, v100, s54, v192
    v_dot2_f32_bf16 v196, v100, v100, v196
    v_dot2_f32_bf16 v193, v101, s54, v193
    v_dot2_f32_bf16 v197, v101, v101, v197
    v_dot2_f32_bf16 v194, v102, s54, v194
    v_dot2_f32_bf16 v198, v102, v102, v198
    v_dot2_f32_bf16 v195, v103, s54, v195
    v_dot2_f32_bf16 v199, v103, v103, v199
    v_dot2_f32_bf16 v192, v104, s54, v192
    v_dot2_f32_bf16 v196, v104, v104, v196
    v_dot2_f32_bf16 v193, v105, s54, v193
    v_dot2_f32_bf16 v197, v105, v105, v197
    v_dot2_f32_bf16 v194, v106, s54, v194
    v_dot2_f32_bf16 v198, v106, v106, v198
    v_dot2_f32_bf16 v195, v107, s54, v195
    v_dot2_f32_bf16 v199, v107, v107, v199
    s_waitcnt lgkmcnt(0)
    s_lshl_b32 s50, s36, 12
    s_add_u32 m0, s50, 131072
    s_add_u32 s44, s29, 1024
    buffer_load_dwordx4 v26, s[16:19], s44 offen lds
    s_add_u32 m0, m0, 1024
    s_add_u32 s44, s44, 9216
    buffer_load_dwordx4 v27, s[16:19], s44 offen lds
    s_add_u32 m0, m0, 1024
    s_add_u32 s44, s44, 9216
    buffer_load_dwordx4 v26, s[16:19], s44 offen lds
    s_add_u32 m0, m0, 1024
    s_add_u32 s44, s44, 9216
    buffer_load_dwordx4 v27, s[16:19], s44 offen lds
    s_mov_b32 s51, 1
    s_mov_b32 s60, s8
    s_mov_b32 s61, s9
    s_mul_i32 s62, s51, 5308416
    v_accvgpr_read_b32 v24, a76
    s_lshl_b32 s59, s42, 7
    v_mul_u32_u24 v24, 9216, v24
    buffer_load_dword a77, v24, s[60:63], s59 offen
    s_mov_b32 s60, s10
    s_mov_b32 s61, s11
    s_mul_i32 s62, s51, 5308416
    v_accvgpr_read_b32 v24, a76
    s_lshl_b32 s59, s42, 7
    v_mul_u32_u24 v24, 9216, v24
    buffer_load_dword a77, v24, s[60:63], s59 offen
    s_waitcnt vmcnt(10)
    ds_read_b128 v[124:127], v12 offset:32768
    ds_read_b128 v[128:131], v13 offset:32768
    ds_read_b128 v[132:135], v14 offset:32768
    ds_read_b128 v[136:139], v15 offset:32768
    v_dot2_f32_bf16 v192, v108, s54, v192
    v_dot2_f32_bf16 v196, v108, v108, v196
    v_dot2_f32_bf16 v193, v109, s54, v193
    v_dot2_f32_bf16 v197, v109, v109, v197
    v_dot2_f32_bf16 v194, v110, s54, v194
    v_dot2_f32_bf16 v198, v110, v110, v198
    v_dot2_f32_bf16 v195, v111, s54, v195
    v_dot2_f32_bf16 v199, v111, v111, v199
    v_dot2_f32_bf16 v192, v112, s54, v192
    v_dot2_f32_bf16 v196, v112, v112, v196
    v_dot2_f32_bf16 v193, v113, s54, v193
    v_dot2_f32_bf16 v197, v113, v113, v197
    v_dot2_f32_bf16 v194, v114, s54, v194
    v_dot2_f32_bf16 v198, v114, v114, v198
    v_dot2_f32_bf16 v195, v115, s54, v195
    v_dot2_f32_bf16 v199, v115, v115, v199
    v_dot2_f32_bf16 v192, v116, s54, v192
    v_dot2_f32_bf16 v196, v116, v116, v196
    v_dot2_f32_bf16 v193, v117, s54, v193
    v_dot2_f32_bf16 v197, v117, v117, v197
    v_dot2_f32_bf16 v194, v118, s54, v194
    v_dot2_f32_bf16 v198, v118, v118, v198
    v_dot2_f32_bf16 v195, v119, s54, v195
    v_dot2_f32_bf16 v199, v119, v119, v199
    v_dot2_f32_bf16 v192, v120, s54, v192
    v_dot2_f32_bf16 v196, v120, v120, v196
    v_dot2_f32_bf16 v193, v121, s54, v193
    v_dot2_f32_bf16 v197, v121, v121, v197
    v_dot2_f32_bf16 v194, v122, s54, v194
    v_dot2_f32_bf16 v198, v122, v122, v198
    v_dot2_f32_bf16 v195, v123, s54, v195
    v_dot2_f32_bf16 v199, v123, v123, v199
    s_waitcnt lgkmcnt(0)
    s_waitcnt vmcnt(6)
    ds_read_b128 v[140:143], v12 offset:49152
    ds_read_b128 v[144:147], v13 offset:49152
    ds_read_b128 v[148:151], v14 offset:49152
    ds_read_b128 v[152:155], v15 offset:49152
    v_dot2_f32_bf16 v192, v124, s54, v192
    v_dot2_f32_bf16 v196, v124, v124, v196
    v_dot2_f32_bf16 v193, v125, s54, v193
    v_dot2_f32_bf16 v197, v125, v125, v197
    v_dot2_f32_bf16 v194, v126, s54, v194
    v_dot2_f32_bf16 v198, v126, v126, v198
    v_dot2_f32_bf16 v195, v127, s54, v195
    v_dot2_f32_bf16 v199, v127, v127, v199
    v_dot2_f32_bf16 v192, v128, s54, v192
    v_dot2_f32_bf16 v196, v128, v128, v196
    v_dot2_f32_bf16 v193, v129, s54, v193
    v_dot2_f32_bf16 v197, v129, v129, v197
    v_dot2_f32_bf16 v194, v130, s54, v194
    v_dot2_f32_bf16 v198, v130, v130, v198
    v_dot2_f32_bf16 v195, v131, s54, v195
    v_dot2_f32_bf16 v199, v131, v131, v199
    v_dot2_f32_bf16 v192, v132, s54, v192
    v_dot2_f32_bf16 v196, v132, v132, v196
    v_dot2_f32_bf16 v193, v133, s54, v193
    v_dot2_f32_bf16 v197, v133, v133, v197
    v_dot2_f32_bf16 v194, v134, s54, v194
    v_dot2_f32_bf16 v198, v134, v134, v198
    v_dot2_f32_bf16 v195, v135, s54, v195
    v_dot2_f32_bf16 v199, v135, v135, v199
    v_dot2_f32_bf16 v192, v136, s54, v192
    v_dot2_f32_bf16 v196, v136, v136, v196
    v_dot2_f32_bf16 v193, v137, s54, v193
    v_dot2_f32_bf16 v197, v137, v137, v197
    v_dot2_f32_bf16 v194, v138, s54, v194
    v_dot2_f32_bf16 v198, v138, v138, v198
    v_dot2_f32_bf16 v195, v139, s54, v195
    v_dot2_f32_bf16 v199, v139, v139, v199
    s_waitcnt lgkmcnt(0)
    s_mov_b32 s20, s6
    s_mov_b32 s21, s7
    s_mov_b32 s22, 1990656
    s_mov_b32 s52, 3456
    s_mul_i32 s44, s36, 82944
    s_lshl_b32 s50, s41, 7
    s_add_u32 s44, s44, s50
    s_mov_b32 s45, 331776
    v_mad_u32_u24 v5, v3, s52, v4
    v_add_u32 v6, 26624, v5
    v_add_u32 v7, 53248, v5
    s_mul_i32 s50, s36, 3072
    s_mov_b32 m0, s50
    s_waitcnt vmcnt(2)
    v_add_u32 v12, 0x10000, v12
    v_add_u32 v13, 0x10000, v13
    v_add_u32 v14, 0x10000, v14
    v_add_u32 v15, 0x10000, v15
    ds_read_b128 v[156:159], v12 offset:0
    ds_read_b128 v[160:163], v13 offset:0
    ds_read_b128 v[164:167], v14 offset:0
    ds_read_b128 v[168:171], v15 offset:0
    v_dot2_f32_bf16 v192, v140, s54, v192
    v_dot2_f32_bf16 v196, v140, v140, v196
    v_dot2_f32_bf16 v193, v141, s54, v193
    v_dot2_f32_bf16 v197, v141, v141, v197
    v_dot2_f32_bf16 v194, v142, s54, v194
    v_dot2_f32_bf16 v198, v142, v142, v198
    v_dot2_f32_bf16 v195, v143, s54, v195
    v_dot2_f32_bf16 v199, v143, v143, v199
    v_dot2_f32_bf16 v192, v144, s54, v192
    v_dot2_f32_bf16 v196, v144, v144, v196
    v_dot2_f32_bf16 v193, v145, s54, v193
    v_dot2_f32_bf16 v197, v145, v145, v197
    v_dot2_f32_bf16 v194, v146, s54, v194
    v_dot2_f32_bf16 v198, v146, v146, v198
    v_dot2_f32_bf16 v195, v147, s54, v195
    v_dot2_f32_bf16 v199, v147, v147, v199
    v_dot2_f32_bf16 v192, v148, s54, v192
    v_dot2_f32_bf16 v196, v148, v148, v196
    v_dot2_f32_bf16 v193, v149, s54, v193
    v_dot2_f32_bf16 v197, v149, v149, v197
    v_dot2_f32_bf16 v194, v150, s54, v194
    v_dot2_f32_bf16 v198, v150, v150, v198
    v_dot2_f32_bf16 v195, v151, s54, v195
    v_dot2_f32_bf16 v199, v151, v151, v199
    v_dot2_f32_bf16 v192, v152, s54, v192
    v_dot2_f32_bf16 v196, v152, v152, v196
    v_dot2_f32_bf16 v193, v153, s54, v193
    v_dot2_f32_bf16 v197, v153, v153, v197
    v_dot2_f32_bf16 v194, v154, s54, v194
    v_dot2_f32_bf16 v198, v154, v154, v198
    v_dot2_f32_bf16 v195, v155, s54, v195
    v_dot2_f32_bf16 v199, v155, v155, v199
    s_waitcnt lgkmcnt(0)
    v_dot2_f32_bf16 v192, v156, s54, v192
    v_dot2_f32_bf16 v196, v156, v156, v196
    v_dot2_f32_bf16 v193, v157, s54, v193
    v_dot2_f32_bf16 v197, v157, v157, v197
    v_dot2_f32_bf16 v194, v158, s54, v194
    v_dot2_f32_bf16 v198, v158, v158, v198
    v_dot2_f32_bf16 v195, v159, s54, v195
    v_dot2_f32_bf16 v199, v159, v159, v199
    v_dot2_f32_bf16 v192, v160, s54, v192
    v_dot2_f32_bf16 v196, v160, v160, v196
    v_dot2_f32_bf16 v193, v161, s54, v193
    v_dot2_f32_bf16 v197, v161, v161, v197
    v_dot2_f32_bf16 v194, v162, s54, v194
    v_dot2_f32_bf16 v198, v162, v162, v198
    v_dot2_f32_bf16 v195, v163, s54, v195
    v_dot2_f32_bf16 v199, v163, v163, v199
    v_dot2_f32_bf16 v192, v164, s54, v192
    v_dot2_f32_bf16 v196, v164, v164, v196
    v_dot2_f32_bf16 v193, v165, s54, v193
    v_dot2_f32_bf16 v197, v165, v165, v197
    v_dot2_f32_bf16 v194, v166, s54, v194
    v_dot2_f32_bf16 v198, v166, v166, v198
    v_dot2_f32_bf16 v195, v167, s54, v195
    v_dot2_f32_bf16 v199, v167, v167, v199
    v_dot2_f32_bf16 v192, v168, s54, v192
    v_dot2_f32_bf16 v196, v168, v168, v196
    v_dot2_f32_bf16 v193, v169, s54, v193
    v_dot2_f32_bf16 v197, v169, v169, v197
    v_dot2_f32_bf16 v194, v170, s54, v194
    v_dot2_f32_bf16 v198, v170, v170, v198
    v_dot2_f32_bf16 v195, v171, s54, v195
    v_dot2_f32_bf16 v199, v171, v171, v199
K1_ARRIVED:
    s_nop 2
    v_add_f32 v192, v192, v193
    v_add_f32 v194, v194, v195
    v_add_f32 v196, v196, v197
    v_add_f32 v198, v198, v199
    v_add_f32 v12, v192, v194
    v_add_f32 v14, v196, v198
    v_mov_b32 v13, v12
    v_mov_b32 v15, v14
    s_nop 1
    v_permlane32_swap_b32 v12, v13
    v_permlane32_swap_b32 v14, v15
    s_nop 1
    v_add_f32 v12, v12, v13
    v_add_f32 v14, v14, v15
    v_mul_f32 v12, 0x3ae38e39, v12
    v_mul_f32 v14, 0x3ae38e39, v14
    v_fma_f32 v14, -v12, v12, v14
    v_max_f32 v14, 0, v14
    v_add_f32 v14, 0x3727c5ac, v14
    v_rsq_f32 v14, v14
    s_nop 0
    v_mul_f32 v14, 0x3fb8aa3b, v14
    v_cvt_pk_bf16_f32 v19, v14, v14
    v_and_b32 v16, 0xffff, v19
    v_lshlrev_b32 v17, 16, v19
    v_rcp_f32 v19, v17
    v_mul_f32 v18, v12, v17
    v_mul_f32 v11, v14, v19
    v_sub_f32 v18, 0, v18
    s_lshl_b32 s50, s36, 7
    s_add_u32 s50, s50, 147456
    v_lshlrev_b32 v20, 2, v20
    v_add_u32 v20, s50, v20
    ds_write_b32 v20, v11
    v_lshlrev_b32 v20, 4, v21
    v_add_u32 v20, s50, v20
    s_waitcnt lgkmcnt(0)
    ds_read_b128 a[80:83], v20 offset:0
    ds_read_b128 a[84:87], v20 offset:32
    ds_read_b128 a[88:91], v20 offset:64
    ds_read_b128 a[92:95], v20 offset:96
    v_mul_f32 v19, v11, v11
    v_rcp_f32 v19, v19
    s_nop 0
    v_mul_f32 v10, 0x40053526, v19
    v_dot2_f32_bf16 v200, v28, v16, v18
    v_dot2_f32_bf16 v201, v28, v17, v18
    v_dot2_f32_bf16 v202, v29, v16, v18
    v_dot2_f32_bf16 v203, v29, v17, v18
    v_dot2_f32_bf16 v204, v30, v16, v18
    v_dot2_f32_bf16 v205, v30, v17, v18
    v_cvt_pk_bf16_f32 v28, v200, v201
    v_dot2_f32_bf16 v206, v31, v16, v18
    v_dot2_f32_bf16 v207, v31, v17, v18
    v_cvt_pk_bf16_f32 v29, v202, v203
    v_dot2_f32_bf16 v200, v32, v16, v18
    v_dot2_f32_bf16 v201, v32, v17, v18
    v_cvt_pk_bf16_f32 v30, v204, v205
    v_dot2_f32_bf16 v202, v33, v16, v18
    v_dot2_f32_bf16 v203, v33, v17, v18
    v_cvt_pk_bf16_f32 v31, v206, v207
    v_dot2_f32_bf16 v204, v34, v16, v18
    v_dot2_f32_bf16 v205, v34, v17, v18
    v_cvt_pk_bf16_f32 v32, v200, v201
    v_dot2_f32_bf16 v206, v35, v16, v18
    v_dot2_f32_bf16 v207, v35, v17, v18
    v_cvt_pk_bf16_f32 v33, v202, v203
    v_dot2_f32_bf16 v200, v36, v16, v18
    v_dot2_f32_bf16 v201, v36, v17, v18
    v_cvt_pk_bf16_f32 v34, v204, v205
    v_dot2_f32_bf16 v202, v37, v16, v18
    v_dot2_f32_bf16 v203, v37, v17, v18
    v_cvt_pk_bf16_f32 v35, v206, v207
    v_dot2_f32_bf16 v204, v38, v16, v18
    v_dot2_f32_bf16 v205, v38, v17, v18
    v_cvt_pk_bf16_f32 v36, v200, v201
    v_dot2_f32_bf16 v206, v39, v16, v18
    v_dot2_f32_bf16 v207, v39, v17, v18
    v_cvt_pk_bf16_f32 v37, v202, v203
    v_dot2_f32_bf16 v200, v40, v16, v18
    v_dot2_f32_bf16 v201, v40, v17, v18
    v_cvt_pk_bf16_f32 v38, v204, v205
    v_dot2_f32_bf16 v202, v41, v16, v18
    v_dot2_f32_bf16 v203, v41, v17, v18
    v_cvt_pk_bf16_f32 v39, v206, v207
    v_dot2_f32_bf16 v204, v42, v16, v18
    v_dot2_f32_bf16 v205, v42, v17, v18
    v_cvt_pk_bf16_f32 v40, v200, v201
    v_dot2_f32_bf16 v206, v43, v16, v18
    v_dot2_f32_bf16 v207, v43, v17, v18
    v_cvt_pk_bf16_f32 v41, v202, v203
    v_dot2_f32_bf16 v200, v44, v16, v18
    v_dot2_f32_bf16 v201, v44, v17, v18
    v_cvt_pk_bf16_f32 v42, v204, v205
    v_dot2_f32_bf16 v202, v45, v16, v18
    v_dot2_f32_bf16 v203, v45, v17, v18
    v_cvt_pk_bf16_f32 v43, v206, v207
    v_dot2_f32_bf16 v204, v46, v16, v18
    v_dot2_f32_bf16 v205, v46, v17, v18
    v_cvt_pk_bf16_f32 v44, v200, v201
    v_dot2_f32_bf16 v206, v47, v16, v18
    v_dot2_f32_bf16 v207, v47, v17, v18
    v_cvt_pk_bf16_f32 v45, v202, v203
    v_dot2_f32_bf16 v200, v48, v16, v18
    v_dot2_f32_bf16 v201, v48, v17, v18
    v_cvt_pk_bf16_f32 v46, v204, v205
    v_dot2_f32_bf16 v202, v49, v16, v18
    v_dot2_f32_bf16 v203, v49, v17, v18
    v_cvt_pk_bf16_f32 v47, v206, v207
    v_dot2_f32_bf16 v204, v50, v16, v18
    v_dot2_f32_bf16 v205, v50, v17, v18
    v_cvt_pk_bf16_f32 v48, v200, v201
    v_dot2_f32_bf16 v206, v51, v16, v18
    v_dot2_f32_bf16 v207, v51, v17, v18
    v_cvt_pk_bf16_f32 v49, v202, v203
    v_dot2_f32_bf16 v200, v52, v16, v18
    v_dot2_f32_bf16 v201, v52, v17, v18
    v_cvt_pk_bf16_f32 v50, v204, v205
    v_dot2_f32_bf16 v202, v53, v16, v18
    v_dot2_f32_bf16 v203, v53, v17, v18
    v_cvt_pk_bf16_f32 v51, v206, v207
    v_dot2_f32_bf16 v204, v54, v16, v18
    v_dot2_f32_bf16 v205, v54, v17, v18
    v_cvt_pk_bf16_f32 v52, v200, v201
    v_dot2_f32_bf16 v206, v55, v16, v18
    v_dot2_f32_bf16 v207, v55, v17, v18
    v_cvt_pk_bf16_f32 v53, v202, v203
    v_dot2_f32_bf16 v200, v56, v16, v18
    v_dot2_f32_bf16 v201, v56, v17, v18
    v_cvt_pk_bf16_f32 v54, v204, v205
    v_dot2_f32_bf16 v202, v57, v16, v18
    v_dot2_f32_bf16 v203, v57, v17, v18
    v_cvt_pk_bf16_f32 v55, v206, v207
    v_dot2_f32_bf16 v204, v58, v16, v18
    v_dot2_f32_bf16 v205, v58, v17, v18
    v_cvt_pk_bf16_f32 v56, v200, v201
    v_dot2_f32_bf16 v206, v59, v16, v18
    v_dot2_f32_bf16 v207, v59, v17, v18
    v_cvt_pk_bf16_f32 v57, v202, v203
    v_dot2_f32_bf16 v200, v60, v16, v18
    v_dot2_f32_bf16 v201, v60, v17, v18
    v_cvt_pk_bf16_f32 v58, v204, v205
    v_dot2_f32_bf16 v202, v61, v16, v18
    v_dot2_f32_bf16 v203, v61, v17, v18
    v_cvt_pk_bf16_f32 v59, v206, v207
    v_dot2_f32_bf16 v204, v62, v16, v18
    v_dot2_f32_bf16 v205, v62, v17, v18
    v_cvt_pk_bf16_f32 v60, v200, v201
    v_dot2_f32_bf16 v206, v63, v16, v18
    v_dot2_f32_bf16 v207, v63, v17, v18
    v_cvt_pk_bf16_f32 v61, v202, v203
    v_dot2_f32_bf16 v200, v64, v16, v18
    v_dot2_f32_bf16 v201, v64, v17, v18
    v_cvt_pk_bf16_f32 v62, v204, v205
    v_dot2_f32_bf16 v202, v65, v16, v18
    v_dot2_f32_bf16 v203, v65, v17, v18
    v_cvt_pk_bf16_f32 v63, v206, v207
    v_dot2_f32_bf16 v204, v66, v16, v18
    v_dot2_f32_bf16 v205, v66, v17, v18
    v_cvt_pk_bf16_f32 v64, v200, v201
    v_dot2_f32_bf16 v206, v67, v16, v18
    v_dot2_f32_bf16 v207, v67, v17, v18
    v_cvt_pk_bf16_f32 v65, v202, v203
    buffer_load_dwordx4 v5, s[20:23], s44 offen offset:0 lds
    buffer_load_dwordx4 v6, s[20:23], s44 offen offset:1024 lds
    buffer_load_dwordx4 v7, s[20:23], s44 offen offset:2048 lds
    s_add_u32 m0, m0, 12288
    s_add_u32 s44, s44, s45
    v_dot2_f32_bf16 v200, v68, v16, v18
    v_dot2_f32_bf16 v201, v68, v17, v18
    v_cvt_pk_bf16_f32 v66, v204, v205
    v_dot2_f32_bf16 v202, v69, v16, v18
    v_dot2_f32_bf16 v203, v69, v17, v18
    v_cvt_pk_bf16_f32 v67, v206, v207
    v_dot2_f32_bf16 v204, v70, v16, v18
    v_dot2_f32_bf16 v205, v70, v17, v18
    v_cvt_pk_bf16_f32 v68, v200, v201
    v_dot2_f32_bf16 v206, v71, v16, v18
    v_dot2_f32_bf16 v207, v71, v17, v18
    v_cvt_pk_bf16_f32 v69, v202, v203
    v_dot2_f32_bf16 v200, v72, v16, v18
    v_dot2_f32_bf16 v201, v72, v17, v18
    v_cvt_pk_bf16_f32 v70, v204, v205
    v_dot2_f32_bf16 v202, v73, v16, v18
    v_dot2_f32_bf16 v203, v73, v17, v18
    v_cvt_pk_bf16_f32 v71, v206, v207
    v_dot2_f32_bf16 v204, v74, v16, v18
    v_dot2_f32_bf16 v205, v74, v17, v18
    v_cvt_pk_bf16_f32 v72, v200, v201
    v_dot2_f32_bf16 v206, v75, v16, v18
    v_dot2_f32_bf16 v207, v75, v17, v18
    v_cvt_pk_bf16_f32 v73, v202, v203
    v_dot2_f32_bf16 v200, v76, v16, v18
    v_dot2_f32_bf16 v201, v76, v17, v18
    v_cvt_pk_bf16_f32 v74, v204, v205
    v_dot2_f32_bf16 v202, v77, v16, v18
    v_dot2_f32_bf16 v203, v77, v17, v18
    v_cvt_pk_bf16_f32 v75, v206, v207
    v_dot2_f32_bf16 v204, v78, v16, v18
    v_dot2_f32_bf16 v205, v78, v17, v18
    v_cvt_pk_bf16_f32 v76, v200, v201
    v_dot2_f32_bf16 v206, v79, v16, v18
    v_dot2_f32_bf16 v207, v79, v17, v18
    v_cvt_pk_bf16_f32 v77, v202, v203
    buffer_load_dwordx4 v5, s[20:23], s44 offen offset:0 lds
    buffer_load_dwordx4 v6, s[20:23], s44 offen offset:1024 lds
    buffer_load_dwordx4 v7, s[20:23], s44 offen offset:2048 lds
    s_add_u32 m0, m0, 12288
    s_add_u32 s44, s44, s45
    v_dot2_f32_bf16 v200, v80, v16, v18
    v_dot2_f32_bf16 v201, v80, v17, v18
    v_cvt_pk_bf16_f32 v78, v204, v205
    v_dot2_f32_bf16 v202, v81, v16, v18
    v_dot2_f32_bf16 v203, v81, v17, v18
    v_cvt_pk_bf16_f32 v79, v206, v207
    v_dot2_f32_bf16 v204, v82, v16, v18
    v_dot2_f32_bf16 v205, v82, v17, v18
    v_cvt_pk_bf16_f32 v80, v200, v201
    v_dot2_f32_bf16 v206, v83, v16, v18
    v_dot2_f32_bf16 v207, v83, v17, v18
    v_cvt_pk_bf16_f32 v81, v202, v203
    v_dot2_f32_bf16 v200, v84, v16, v18
    v_dot2_f32_bf16 v201, v84, v17, v18
    v_cvt_pk_bf16_f32 v82, v204, v205
    v_dot2_f32_bf16 v202, v85, v16, v18
    v_dot2_f32_bf16 v203, v85, v17, v18
    v_cvt_pk_bf16_f32 v83, v206, v207
    v_dot2_f32_bf16 v204, v86, v16, v18
    v_dot2_f32_bf16 v205, v86, v17, v18
    v_cvt_pk_bf16_f32 v84, v200, v201
    v_dot2_f32_bf16 v206, v87, v16, v18
    v_dot2_f32_bf16 v207, v87, v17, v18
    v_cvt_pk_bf16_f32 v85, v202, v203
    v_dot2_f32_bf16 v200, v88, v16, v18
    v_dot2_f32_bf16 v201, v88, v17, v18
    v_cvt_pk_bf16_f32 v86, v204, v205
    v_dot2_f32_bf16 v202, v89, v16, v18
    v_dot2_f32_bf16 v203, v89, v17, v18
    v_cvt_pk_bf16_f32 v87, v206, v207
    v_dot2_f32_bf16 v204, v90, v16, v18
    v_dot2_f32_bf16 v205, v90, v17, v18
    v_cvt_pk_bf16_f32 v88, v200, v201
    v_dot2_f32_bf16 v206, v91, v16, v18
    v_dot2_f32_bf16 v207, v91, v17, v18
    v_cvt_pk_bf16_f32 v89, v202, v203
    buffer_load_dwordx4 v5, s[20:23], s44 offen offset:0 lds
    buffer_load_dwordx4 v6, s[20:23], s44 offen offset:1024 lds
    buffer_load_dwordx4 v7, s[20:23], s44 offen offset:2048 lds
    s_add_u32 m0, m0, 12288
    s_add_u32 s44, s44, s45
    v_dot2_f32_bf16 v200, v92, v16, v18
    v_dot2_f32_bf16 v201, v92, v17, v18
    v_cvt_pk_bf16_f32 v90, v204, v205
    v_dot2_f32_bf16 v202, v93, v16, v18
    v_dot2_f32_bf16 v203, v93, v17, v18
    v_cvt_pk_bf16_f32 v91, v206, v207
    v_dot2_f32_bf16 v204, v94, v16, v18
    v_dot2_f32_bf16 v205, v94, v17, v18
    v_cvt_pk_bf16_f32 v92, v200, v201
    v_dot2_f32_bf16 v206, v95, v16, v18
    v_dot2_f32_bf16 v207, v95, v17, v18
    v_cvt_pk_bf16_f32 v93, v202, v203
    v_dot2_f32_bf16 v200, v96, v16, v18
    v_dot2_f32_bf16 v201, v96, v17, v18
    v_cvt_pk_bf16_f32 v94, v204, v205
    v_dot2_f32_bf16 v202, v97, v16, v18
    v_dot2_f32_bf16 v203, v97, v17, v18
    v_cvt_pk_bf16_f32 v95, v206, v207
    v_dot2_f32_bf16 v204, v98, v16, v18
    v_dot2_f32_bf16 v205, v98, v17, v18
    v_cvt_pk_bf16_f32 v96, v200, v201
    v_dot2_f32_bf16 v206, v99, v16, v18
    v_dot2_f32_bf16 v207, v99, v17, v18
    v_cvt_pk_bf16_f32 v97, v202, v203
    v_dot2_f32_bf16 v200, v100, v16, v18
    v_dot2_f32_bf16 v201, v100, v17, v18
    v_cvt_pk_bf16_f32 v98, v204, v205
    v_dot2_f32_bf16 v202, v101, v16, v18
    v_dot2_f32_bf16 v203, v101, v17, v18
    v_cvt_pk_bf16_f32 v99, v206, v207
    v_dot2_f32_bf16 v204, v102, v16, v18
    v_dot2_f32_bf16 v205, v102, v17, v18
    v_cvt_pk_bf16_f32 v100, v200, v201
    v_dot2_f32_bf16 v206, v103, v16, v18
    v_dot2_f32_bf16 v207, v103, v17, v18
    v_cvt_pk_bf16_f32 v101, v202, v203
    buffer_load_dwordx4 v5, s[20:23], s44 offen offset:0 lds
    buffer_load_dwordx4 v6, s[20:23], s44 offen offset:1024 lds
    buffer_load_dwordx4 v7, s[20:23], s44 offen offset:2048 lds
    s_add_u32 m0, m0, 12288
    s_add_u32 s44, s44, s45
    v_dot2_f32_bf16 v200, v104, v16, v18
    v_dot2_f32_bf16 v201, v104, v17, v18
    v_cvt_pk_bf16_f32 v102, v204, v205
    v_dot2_f32_bf16 v202, v105, v16, v18
    v_dot2_f32_bf16 v203, v105, v17, v18
    v_cvt_pk_bf16_f32 v103, v206, v207
    v_dot2_f32_bf16 v204, v106, v16, v18
    v_dot2_f32_bf16 v205, v106, v17, v18
    v_cvt_pk_bf16_f32 v104, v200, v201
    v_dot2_f32_bf16 v206, v107, v16, v18
    v_dot2_f32_bf16 v207, v107, v17, v18
    v_cvt_pk_bf16_f32 v105, v202, v203
    v_dot2_f32_bf16 v200, v108, v16, v18
    v_dot2_f32_bf16 v201, v108, v17, v18
    v_cvt_pk_bf16_f32 v106, v204, v205
    v_dot2_f32_bf16 v202, v109, v16, v18
    v_dot2_f32_bf16 v203, v109, v17, v18
    v_cvt_pk_bf16_f32 v107, v206, v207
    v_dot2_f32_bf16 v204, v110, v16, v18
    v_dot2_f32_bf16 v205, v110, v17, v18
    v_cvt_pk_bf16_f32 v108, v200, v201
    v_dot2_f32_bf16 v206, v111, v16, v18
    v_dot2_f32_bf16 v207, v111, v17, v18
    v_cvt_pk_bf16_f32 v109, v202, v203
    v_dot2_f32_bf16 v200, v112, v16, v18
    v_dot2_f32_bf16 v201, v112, v17, v18
    v_cvt_pk_bf16_f32 v110, v204, v205
    v_dot2_f32_bf16 v202, v113, v16, v18
    v_dot2_f32_bf16 v203, v113, v17, v18
    v_cvt_pk_bf16_f32 v111, v206, v207
    v_dot2_f32_bf16 v204, v114, v16, v18
    v_dot2_f32_bf16 v205, v114, v17, v18
    v_cvt_pk_bf16_f32 v112, v200, v201
    v_dot2_f32_bf16 v206, v115, v16, v18
    v_dot2_f32_bf16 v207, v115, v17, v18
    v_cvt_pk_bf16_f32 v113, v202, v203
    buffer_load_dwordx4 v5, s[20:23], s44 offen offset:0 lds
    buffer_load_dwordx4 v6, s[20:23], s44 offen offset:1024 lds
    buffer_load_dwordx4 v7, s[20:23], s44 offen offset:2048 lds
    s_add_u32 m0, m0, 12288
    s_add_u32 s44, s44, s45
    v_dot2_f32_bf16 v200, v116, v16, v18
    v_dot2_f32_bf16 v201, v116, v17, v18
    v_cvt_pk_bf16_f32 v114, v204, v205
    v_dot2_f32_bf16 v202, v117, v16, v18
    v_dot2_f32_bf16 v203, v117, v17, v18
    v_cvt_pk_bf16_f32 v115, v206, v207
    v_dot2_f32_bf16 v204, v118, v16, v18
    v_dot2_f32_bf16 v205, v118, v17, v18
    v_cvt_pk_bf16_f32 v116, v200, v201
    v_dot2_f32_bf16 v206, v119, v16, v18
    v_dot2_f32_bf16 v207, v119, v17, v18
    v_cvt_pk_bf16_f32 v117, v202, v203
    v_dot2_f32_bf16 v200, v120, v16, v18
    v_dot2_f32_bf16 v201, v120, v17, v18
    v_cvt_pk_bf16_f32 v118, v204, v205
    v_dot2_f32_bf16 v202, v121, v16, v18
    v_dot2_f32_bf16 v203, v121, v17, v18
    v_cvt_pk_bf16_f32 v119, v206, v207
    v_dot2_f32_bf16 v204, v122, v16, v18
    v_dot2_f32_bf16 v205, v122, v17, v18
    v_cvt_pk_bf16_f32 v120, v200, v201
    v_dot2_f32_bf16 v206, v123, v16, v18
    v_dot2_f32_bf16 v207, v123, v17, v18
    v_cvt_pk_bf16_f32 v121, v202, v203
    v_dot2_f32_bf16 v200, v124, v16, v18
    v_dot2_f32_bf16 v201, v124, v17, v18
    v_cvt_pk_bf16_f32 v122, v204, v205
    v_dot2_f32_bf16 v202, v125, v16, v18
    v_dot2_f32_bf16 v203, v125, v17, v18
    v_cvt_pk_bf16_f32 v123, v206, v207
    v_dot2_f32_bf16 v204, v126, v16, v18
    v_dot2_f32_bf16 v205, v126, v17, v18
    v_cvt_pk_bf16_f32 v124, v200, v201
    v_dot2_f32_bf16 v206, v127, v16, v18
    v_dot2_f32_bf16 v207, v127, v17, v18
    v_cvt_pk_bf16_f32 v125, v202, v203
    buffer_load_dwordx4 v5, s[20:23], s44 offen offset:0 lds
    buffer_load_dwordx4 v6, s[20:23], s44 offen offset:1024 lds
    buffer_load_dwordx4 v7, s[20:23], s44 offen offset:2048 lds
    s_add_u32 m0, m0, 12288
    s_add_u32 s44, s44, s45
    v_dot2_f32_bf16 v200, v128, v16, v18
    v_dot2_f32_bf16 v201, v128, v17, v18
    v_cvt_pk_bf16_f32 v126, v204, v205
    v_dot2_f32_bf16 v202, v129, v16, v18
    v_dot2_f32_bf16 v203, v129, v17, v18
    v_cvt_pk_bf16_f32 v127, v206, v207
    v_dot2_f32_bf16 v204, v130, v16, v18
    v_dot2_f32_bf16 v205, v130, v17, v18
    v_cvt_pk_bf16_f32 v128, v200, v201
    v_dot2_f32_bf16 v206, v131, v16, v18
    v_dot2_f32_bf16 v207, v131, v17, v18
    v_cvt_pk_bf16_f32 v129, v202, v203
    v_dot2_f32_bf16 v200, v132, v16, v18
    v_dot2_f32_bf16 v201, v132, v17, v18
    v_cvt_pk_bf16_f32 v130, v204, v205
    v_dot2_f32_bf16 v202, v133, v16, v18
    v_dot2_f32_bf16 v203, v133, v17, v18
    v_cvt_pk_bf16_f32 v131, v206, v207
    v_dot2_f32_bf16 v204, v134, v16, v18
    v_dot2_f32_bf16 v205, v134, v17, v18
    v_cvt_pk_bf16_f32 v132, v200, v201
    v_dot2_f32_bf16 v206, v135, v16, v18
    v_dot2_f32_bf16 v207, v135, v17, v18
    v_cvt_pk_bf16_f32 v133, v202, v203
    v_dot2_f32_bf16 v200, v136, v16, v18
    v_dot2_f32_bf16 v201, v136, v17, v18
    v_cvt_pk_bf16_f32 v134, v204, v205
    v_dot2_f32_bf16 v202, v137, v16, v18
    v_dot2_f32_bf16 v203, v137, v17, v18
    v_cvt_pk_bf16_f32 v135, v206, v207
    v_dot2_f32_bf16 v204, v138, v16, v18
    v_dot2_f32_bf16 v205, v138, v17, v18
    v_cvt_pk_bf16_f32 v136, v200, v201
    v_dot2_f32_bf16 v206, v139, v16, v18
    v_dot2_f32_bf16 v207, v139, v17, v18
    v_cvt_pk_bf16_f32 v137, v202, v203
    s_mov_b32 s43, 1
    s_cmp_lt_u32 s43, s39
    s_cselect_b32 s51, 1, 0
    s_add_u32 s55, s41, s43
    s_mov_b32 s60, s6
    s_mov_b32 s61, s7
    s_mul_i32 s62, s51, 1990656
    v_accvgpr_read_b32 v24, a76
    s_lshl_b32 s59, s55, 7
    v_mul_u32_u24 v24, 3456, v24
    buffer_load_dword a77, v24, s[60:63], s59 offen
    s_cmp_lt_u32 s43, s40
    s_cselect_b32 s51, 1, 0
    s_add_u32 s55, s42, s43
    s_mov_b32 s60, s8
    s_mov_b32 s61, s9
    s_mul_i32 s62, s51, 5308416
    v_accvgpr_read_b32 v24, a76
    s_lshl_b32 s59, s55, 7
    v_mul_u32_u24 v24, 9216, v24
    buffer_load_dword a77, v24, s[60:63], s59 offen
    s_mov_b32 s60, s10
    s_mov_b32 s61, s11
    s_mul_i32 s62, s51, 5308416
    v_accvgpr_read_b32 v24, a76
    s_lshl_b32 s59, s55, 7
    v_mul_u32_u24 v24, 9216, v24
    buffer_load_dword a77, v24, s[60:63], s59 offen
    v_dot2_f32_bf16 v200, v140, v16, v18
    v_dot2_f32_bf16 v201, v140, v17, v18
    v_cvt_pk_bf16_f32 v138, v204, v205
    v_dot2_f32_bf16 v202, v141, v16, v18
    v_dot2_f32_bf16 v203, v141, v17, v18
    v_cvt_pk_bf16_f32 v139, v206, v207
    v_dot2_f32_bf16 v204, v142, v16, v18
    v_dot2_f32_bf16 v205, v142, v17, v18
    v_cvt_pk_bf16_f32 v140, v200, v201
    v_dot2_f32_bf16 v206, v143, v16, v18
    v_dot2_f32_bf16 v207, v143, v17, v18
    v_cvt_pk_bf16_f32 v141, v202, v203
    v_dot2_f32_bf16 v200, v144, v16, v18
    v_dot2_f32_bf16 v201, v144, v17, v18
    v_cvt_pk_bf16_f32 v142, v204, v205
    v_dot2_f32_bf16 v202, v145, v16, v18
    v_dot2_f32_bf16 v203, v145, v17, v18
    v_cvt_pk_bf16_f32 v143, v206, v207
    v_dot2_f32_bf16 v204, v146, v16, v18
    v_dot2_f32_bf16 v205, v146, v17, v18
    v_cvt_pk_bf16_f32 v144, v200, v201
    v_dot2_f32_bf16 v206, v147, v16, v18
    v_dot2_f32_bf16 v207, v147, v17, v18
    v_cvt_pk_bf16_f32 v145, v202, v203
    v_dot2_f32_bf16 v200, v148, v16, v18
    v_dot2_f32_bf16 v201, v148, v17, v18
    v_cvt_pk_bf16_f32 v146, v204, v205
    v_dot2_f32_bf16 v202, v149, v16, v18
    v_dot2_f32_bf16 v203, v149, v17, v18
    v_cvt_pk_bf16_f32 v147, v206, v207
    v_dot2_f32_bf16 v204, v150, v16, v18
    v_dot2_f32_bf16 v205, v150, v17, v18
    v_cvt_pk_bf16_f32 v148, v200, v201
    v_dot2_f32_bf16 v206, v151, v16, v18
    v_dot2_f32_bf16 v207, v151, v17, v18
    v_cvt_pk_bf16_f32 v149, v202, v203
    v_dot2_f32_bf16 v200, v152, v16, v18
    v_dot2_f32_bf16 v201, v152, v17, v18
    v_cvt_pk_bf16_f32 v150, v204, v205
    v_dot2_f32_bf16 v202, v153, v16, v18
    v_dot2_f32_bf16 v203, v153, v17, v18
    v_cvt_pk_bf16_f32 v151, v206, v207
    v_dot2_f32_bf16 v204, v154, v16, v18
    v_dot2_f32_bf16 v205, v154, v17, v18
    v_cvt_pk_bf16_f32 v152, v200, v201
    v_dot2_f32_bf16 v206, v155, v16, v18
    v_dot2_f32_bf16 v207, v155, v17, v18
    v_cvt_pk_bf16_f32 v153, v202, v203
    v_dot2_f32_bf16 v200, v156, v16, v18
    v_dot2_f32_bf16 v201, v156, v17, v18
    v_cvt_pk_bf16_f32 v154, v204, v205
    v_dot2_f32_bf16 v202, v157, v16, v18
    v_dot2_f32_bf16 v203, v157, v17, v18
    v_cvt_pk_bf16_f32 v155, v206, v207
    v_dot2_f32_bf16 v204, v158, v16, v18
    v_dot2_f32_bf16 v205, v158, v17, v18
    v_cvt_pk_bf16_f32 v156, v200, v201
    v_dot2_f32_bf16 v206, v159, v16, v18
    v_dot2_f32_bf16 v207, v159, v17, v18
    v_cvt_pk_bf16_f32 v157, v202, v203
    v_dot2_f32_bf16 v200, v160, v16, v18
    v_dot2_f32_bf16 v201, v160, v17, v18
    v_cvt_pk_bf16_f32 v158, v204, v205
    v_dot2_f32_bf16 v202, v161, v16, v18
    v_dot2_f32_bf16 v203, v161, v17, v18
    v_cvt_pk_bf16_f32 v159, v206, v207
    v_dot2_f32_bf16 v204, v162, v16, v18
    v_dot2_f32_bf16 v205, v162, v17, v18
    v_cvt_pk_bf16_f32 v160, v200, v201
    v_dot2_f32_bf16 v206, v163, v16, v18
    v_dot2_f32_bf16 v207, v163, v17, v18
    v_cvt_pk_bf16_f32 v161, v202, v203
    v_dot2_f32_bf16 v200, v164, v16, v18
    v_dot2_f32_bf16 v201, v164, v17, v18
    v_cvt_pk_bf16_f32 v162, v204, v205
    v_dot2_f32_bf16 v202, v165, v16, v18
    v_dot2_f32_bf16 v203, v165, v17, v18
    v_cvt_pk_bf16_f32 v163, v206, v207
    v_dot2_f32_bf16 v204, v166, v16, v18
    v_dot2_f32_bf16 v205, v166, v17, v18
    v_cvt_pk_bf16_f32 v164, v200, v201
    v_dot2_f32_bf16 v206, v167, v16, v18
    v_dot2_f32_bf16 v207, v167, v17, v18
    v_cvt_pk_bf16_f32 v165, v202, v203
    v_dot2_f32_bf16 v200, v168, v16, v18
    v_dot2_f32_bf16 v201, v168, v17, v18
    v_cvt_pk_bf16_f32 v166, v204, v205
    v_dot2_f32_bf16 v202, v169, v16, v18
    v_dot2_f32_bf16 v203, v169, v17, v18
    v_cvt_pk_bf16_f32 v167, v206, v207
    v_dot2_f32_bf16 v204, v170, v16, v18
    v_dot2_f32_bf16 v205, v170, v17, v18
    v_cvt_pk_bf16_f32 v168, v200, v201
    v_dot2_f32_bf16 v206, v171, v16, v18
    v_dot2_f32_bf16 v207, v171, v17, v18
    v_cvt_pk_bf16_f32 v169, v202, v203
    s_nop 2
    v_cvt_pk_bf16_f32 v170, v204, v205
    v_cvt_pk_bf16_f32 v171, v206, v207
    s_nop 0
    v_accvgpr_write_b32 a0, v160
    v_accvgpr_write_b32 a1, v161
    v_accvgpr_write_b32 a2, v162
    v_accvgpr_write_b32 a3, v163
    v_accvgpr_write_b32 a4, v164
    v_accvgpr_write_b32 a5, v165
    v_accvgpr_write_b32 a6, v166
    v_accvgpr_write_b32 a7, v167
    v_accvgpr_write_b32 a8, v168
    v_accvgpr_write_b32 a9, v169
    v_accvgpr_write_b32 a10, v170
    v_accvgpr_write_b32 a11, v171
    s_waitcnt vmcnt(3)
    s_barrier
    ds_read_b64_tr_b16 a[44:45], v1 offset:0
    ds_read_b64_tr_b16 a[46:47], v1 offset:512
    ds_read_b64_tr_b16 a[48:49], v2 offset:0
    ds_read_b64_tr_b16 a[50:51], v2 offset:512
    ds_read_b64_tr_b16 a[52:53], v1 offset:2048
    ds_read_b64_tr_b16 a[54:55], v1 offset:2560
    ds_read_b64_tr_b16 a[56:57], v2 offset:2048
    ds_read_b64_tr_b16 a[58:59], v2 offset:2560
    ds_read_b64_tr_b16 a[60:61], v1 offset:4096
    ds_read_b64_tr_b16 a[62:63], v1 offset:4608
    ds_read_b64_tr_b16 a[64:65], v2 offset:4096
    ds_read_b64_tr_b16 a[66:67], v2 offset:4608
    s_mov_b32 s19, 0x00020000
    s_mov_b32 s53, 73728
    s_mov_b32 s43, 0
    s_mov_b32 s55, s41
K1_BODIES:
K1_LOOP:
    s_cmp_lt_u32 s43, s39
    s_cbranch_scc0 K1_NOQ
    s_waitcnt lgkmcnt(4)
    v_mfma_f32_32x32x16_bf16 a[12:27], v[28:31], a[44:47], 0
    ds_read_b64_tr_b16 a[68:69], v1 offset:6144
    ds_read_b64_tr_b16 a[70:71], v1 offset:6656
    s_add_u32 s51, s42, s43
    s_mov_b32 s20, s8
    s_mov_b32 s21, s9
    s_mov_b32 s22, 5308416
    v_mfma_f32_32x32x16_bf16 a[28:43], v[28:31], a[48:51], 0
    ds_read_b64_tr_b16 a[72:73], v2 offset:6144
    ds_read_b64_tr_b16 a[74:75], v2 offset:6656
    s_mov_b32 s52, 9216
    s_mul_i32 s44, s36, 221184
    s_lshl_b32 s50, s51, 7
    s_add_u32 s44, s44, s50
    v_mfma_f32_32x32x16_bf16 a[12:27], v[32:35], a[52:55], a[12:27]
    ds_read_b64_tr_b16 a[44:45], v1 offset:8192
    ds_read_b64_tr_b16 a[46:47], v1 offset:8704
    s_mov_b32 s45, 884736
    v_mad_u32_u24 v5, v3, s52, v4
    v_add_u32 v6, 72704, v5
    v_add_u32 v7, 145408, v5
    v_mfma_f32_32x32x16_bf16 a[28:43], v[32:35], a[56:59], a[28:43]
    ds_read_b64_tr_b16 a[48:49], v2 offset:8192
    ds_read_b64_tr_b16 a[50:51], v2 offset:8704
    s_mul_i32 s50, s36, 3072
    s_add_u32 m0, s53, s50
    s_lshl_b32 s50, s53, 1
    s_waitcnt lgkmcnt(4)
    v_mfma_f32_32x32x16_bf16 a[12:27], v[36:39], a[60:63], a[12:27]
    ds_read_b64_tr_b16 a[52:53], v1 offset:10240
    ds_read_b64_tr_b16 a[54:55], v1 offset:10752
    s_sub_u32 s46, s50, 139264
    s_sub_u32 s53, 73728, s53
    v_mfma_f32_32x32x16_bf16 a[28:43], v[36:39], a[64:67], a[28:43]
    ds_read_b64_tr_b16 a[56:57], v2 offset:10240
    ds_read_b64_tr_b16 a[58:59], v2 offset:10752
    buffer_load_dwordx4 v5, s[20:23], s44 offen offset:0 lds
    v_mfma_f32_32x32x16_bf16 a[12:27], v[40:43], a[68:71], a[12:27]
    ds_read_b64_tr_b16 a[60:61], v1 offset:12288
    ds_read_b64_tr_b16 a[62:63], v1 offset:12800
    buffer_load_dwordx4 v6, s[20:23], s44 offen offset:1024 lds
    v_mfma_f32_32x32x16_bf16 a[28:43], v[40:43], a[72:75], a[28:43]
    ds_read_b64_tr_b16 a[64:65], v2 offset:12288
    ds_read_b64_tr_b16 a[66:67], v2 offset:12800
    buffer_load_dwordx4 v7, s[20:23], s44 offen offset:2048 lds
    s_waitcnt lgkmcnt(4)
    v_mfma_f32_32x32x16_bf16 a[12:27], v[44:47], a[44:47], a[12:27]
    ds_read_b64_tr_b16 a[68:69], v1 offset:14336
    ds_read_b64_tr_b16 a[70:71], v1 offset:14848
    s_add_u32 m0, m0, 12288
    v_mfma_f32_32x32x16_bf16 a[28:43], v[44:47], a[48:51], a[28:43]
    ds_read_b64_tr_b16 a[72:73], v2 offset:14336
    ds_read_b64_tr_b16 a[74:75], v2 offset:14848
    s_add_u32 s44, s44, s45
    v_mfma_f32_32x32x16_bf16 a[12:27], v[48:51], a[52:55], a[12:27]
    ds_read_b64_tr_b16 a[44:45], v1 offset:16384
    ds_read_b64_tr_b16 a[46:47], v1 offset:16896
    buffer_load_dwordx4 v5, s[20:23], s44 offen offset:0 lds
    v_mfma_f32_32x32x16_bf16 a[28:43], v[48:51], a[56:59], a[28:43]
    ds_read_b64_tr_b16 a[48:49], v2 offset:16384
    ds_read_b64_tr_b16 a[50:51], v2 offset:16896
    buffer_load_dwordx4 v6, s[20:23], s44 offen offset:1024 lds
    s_waitcnt lgkmcnt(4)
    v_mfma_f32_32x32x16_bf16 a[12:27], v[52:55], a[60:63], a[12:27]
    ds_read_b64_tr_b16 a[52:53], v1 offset:18432
    ds_read_b64_tr_b16 a[54:55], v1 offset:18944
    buffer_load_dwordx4 v7, s[20:23], s44 offen offset:2048 lds
    v_mfma_f32_32x32x16_bf16 a[28:43], v[52:55], a[64:67], a[28:43]
    ds_read_b64_tr_b16 a[56:57], v2 offset:18432
    ds_read_b64_tr_b16 a[58:59], v2 offset:18944
    s_add_u32 m0, m0, 12288
    v_mfma_f32_32x32x16_bf16 a[12:27], v[56:59], a[68:71], a[12:27]
    ds_read_b64_tr_b16 a[60:61], v1 offset:20480
    ds_read_b64_tr_b16 a[62:63], v1 offset:20992
    s_add_u32 s44, s44, s45
    v_mfma_f32_32x32x16_bf16 a[28:43], v[56:59], a[72:75], a[28:43]
    ds_read_b64_tr_b16 a[64:65], v2 offset:20480
    ds_read_b64_tr_b16 a[66:67], v2 offset:20992
    buffer_load_dwordx4 v5, s[20:23], s44 offen offset:0 lds
    s_waitcnt lgkmcnt(4)
    v_mfma_f32_32x32x16_bf16 a[12:27], v[60:63], a[44:47], a[12:27]
    ds_read_b64_tr_b16 a[68:69], v1 offset:22528
    ds_read_b64_tr_b16 a[70:71], v1 offset:23040
    buffer_load_dwordx4 v6, s[20:23], s44 offen offset:1024 lds
    v_mfma_f32_32x32x16_bf16 a[28:43], v[60:63], a[48:51], a[28:43]
    ds_read_b64_tr_b16 a[72:73], v2 offset:22528
    ds_read_b64_tr_b16 a[74:75], v2 offset:23040
    buffer_load_dwordx4 v7, s[20:23], s44 offen offset:2048 lds
    v_mfma_f32_32x32x16_bf16 a[12:27], v[64:67], a[52:55], a[12:27]
    ds_read_b64_tr_b16 a[44:45], v1 offset:24576
    ds_read_b64_tr_b16 a[46:47], v1 offset:25088
    s_add_u32 m0, m0, 12288
    v_mfma_f32_32x32x16_bf16 a[28:43], v[64:67], a[56:59], a[28:43]
    ds_read_b64_tr_b16 a[48:49], v2 offset:24576
    ds_read_b64_tr_b16 a[50:51], v2 offset:25088
    s_add_u32 s44, s44, s45
    s_waitcnt lgkmcnt(4)
    v_mfma_f32_32x32x16_bf16 a[12:27], v[68:71], a[60:63], a[12:27]
    ds_read_b64_tr_b16 a[52:53], v1 offset:26624
    ds_read_b64_tr_b16 a[54:55], v1 offset:27136
    buffer_load_dwordx4 v5, s[20:23], s44 offen offset:0 lds
    v_mfma_f32_32x32x16_bf16 a[28:43], v[68:71], a[64:67], a[28:43]
    ds_read_b64_tr_b16 a[56:57], v2 offset:26624
    ds_read_b64_tr_b16 a[58:59], v2 offset:27136
    buffer_load_dwordx4 v6, s[20:23], s44 offen offset:1024 lds
    v_mfma_f32_32x32x16_bf16 a[12:27], v[72:75], a[68:71], a[12:27]
    ds_read_b64_tr_b16 a[60:61], v1 offset:28672
    ds_read_b64_tr_b16 a[62:63], v1 offset:29184
    buffer_load_dwordx4 v7, s[20:23], s44 offen offset:2048 lds
    v_mfma_f32_32x32x16_bf16 a[28:43], v[72:75], a[72:75], a[28:43]
    ds_read_b64_tr_b16 a[64:65], v2 offset:28672
    ds_read_b64_tr_b16 a[66:67], v2 offset:29184
    s_add_u32 m0, m0, 12288
    s_waitcnt lgkmcnt(4)
    v_mfma_f32_32x32x16_bf16 a[12:27], v[76:79], a[44:47], a[12:27]
    ds_read_b64_tr_b16 a[68:69], v1 offset:30720
    ds_read_b64_tr_b16 a[70:71], v1 offset:31232
    s_add_u32 s44, s44, s45
    v_mfma_f32_32x32x16_bf16 a[28:43], v[76:79], a[48:51], a[28:43]
    ds_read_b64_tr_b16 a[72:73], v2 offset:30720
    ds_read_b64_tr_b16 a[74:75], v2 offset:31232
    buffer_load_dwordx4 v5, s[20:23], s44 offen offset:0 lds
    v_mfma_f32_32x32x16_bf16 a[12:27], v[80:83], a[52:55], a[12:27]
    ds_read_b64_tr_b16 a[44:45], v1 offset:32768
    ds_read_b64_tr_b16 a[46:47], v1 offset:33280
    buffer_load_dwordx4 v6, s[20:23], s44 offen offset:1024 lds
    v_mul_f32 v192, v224, v192
    v_mfma_f32_32x32x16_bf16 a[28:43], v[80:83], a[56:59], a[28:43]
    ds_read_b64_tr_b16 a[48:49], v2 offset:32768
    ds_read_b64_tr_b16 a[50:51], v2 offset:33280
    buffer_load_dwordx4 v7, s[20:23], s44 offen offset:2048 lds
    v_mul_f32 v193, v225, v193
    s_waitcnt lgkmcnt(4)
    v_mfma_f32_32x32x16_bf16 a[12:27], v[84:87], a[60:63], a[12:27]
    ds_read_b64_tr_b16 a[52:53], v1 offset:34816
    ds_read_b64_tr_b16 a[54:55], v1 offset:35328
    s_add_u32 m0, m0, 12288
    v_mul_f32 v194, v226, v194
    v_mfma_f32_32x32x16_bf16 a[28:43], v[84:87], a[64:67], a[28:43]
    ds_read_b64_tr_b16 a[56:57], v2 offset:34816
    ds_read_b64_tr_b16 a[58:59], v2 offset:35328
    s_add_u32 s44, s44, s45
    v_mul_f32 v195, v227, v195
    v_mul_f32 v196, v228, v196
    v_mfma_f32_32x32x16_bf16 a[12:27], v[88:91], a[68:71], a[12:27]
    ds_read_b64_tr_b16 a[60:61], v1 offset:36864
    ds_read_b64_tr_b16 a[62:63], v1 offset:37376
    buffer_load_dwordx4 v5, s[20:23], s44 offen offset:0 lds
    v_mul_f32 v197, v229, v197
    v_mfma_f32_32x32x16_bf16 a[28:43], v[88:91], a[72:75], a[28:43]
    ds_read_b64_tr_b16 a[64:65], v2 offset:36864
    ds_read_b64_tr_b16 a[66:67], v2 offset:37376
    buffer_load_dwordx4 v6, s[20:23], s44 offen offset:1024 lds
    v_mul_f32 v198, v230, v198
    s_waitcnt lgkmcnt(4)
    v_mfma_f32_32x32x16_bf16 a[12:27], v[92:95], a[44:47], a[12:27]
    ds_read_b64_tr_b16 a[68:69], v1 offset:38912
    ds_read_b64_tr_b16 a[70:71], v1 offset:39424
    buffer_load_dwordx4 v7, s[20:23], s44 offen offset:2048 lds
    v_mul_f32 v199, v231, v199
    v_cvt_pk_bf16_f32 v224, v192, v193
    v_mfma_f32_32x32x16_bf16 a[28:43], v[92:95], a[48:51], a[28:43]
    ds_read_b64_tr_b16 a[72:73], v2 offset:38912
    ds_read_b64_tr_b16 a[74:75], v2 offset:39424
    s_add_u32 m0, m0, 12288
    v_cvt_pk_bf16_f32 v225, v194, v195
    v_mfma_f32_32x32x16_bf16 a[12:27], v[96:99], a[52:55], a[12:27]
    ds_read_b64_tr_b16 a[44:45], v1 offset:40960
    ds_read_b64_tr_b16 a[46:47], v1 offset:41472
    s_add_u32 s44, s44, s45
    v_cvt_pk_bf16_f32 v226, v196, v197
    v_cvt_pk_bf16_f32 v227, v198, v199
    v_mfma_f32_32x32x16_bf16 a[28:43], v[96:99], a[56:59], a[28:43]
    ds_read_b64_tr_b16 a[48:49], v2 offset:40960
    ds_read_b64_tr_b16 a[50:51], v2 offset:41472
    buffer_store_dwordx4 v[224:227], v8, s[32:35], s47 offen offset:0 sc1
    s_waitcnt lgkmcnt(4)
    v_mfma_f32_32x32x16_bf16 a[12:27], v[100:103], a[60:63], a[12:27]
    ds_read_b64_tr_b16 a[52:53], v1 offset:43008
    ds_read_b64_tr_b16 a[54:55], v1 offset:43520
    v_mul_f32 v200, v232, v200
    v_mfma_f32_32x32x16_bf16 a[28:43], v[100:103], a[64:67], a[28:43]
    ds_read_b64_tr_b16 a[56:57], v2 offset:43008
    ds_read_b64_tr_b16 a[58:59], v2 offset:43520
    v_mul_f32 v201, v233, v201
    v_mul_f32 v202, v234, v202
    v_mfma_f32_32x32x16_bf16 a[12:27], v[104:107], a[68:71], a[12:27]
    ds_read_b64_tr_b16 a[60:61], v1 offset:45056
    ds_read_b64_tr_b16 a[62:63], v1 offset:45568
    v_mul_f32 v203, v235, v203
    v_mfma_f32_32x32x16_bf16 a[28:43], v[104:107], a[72:75], a[28:43]
    ds_read_b64_tr_b16 a[64:65], v2 offset:45056
    ds_read_b64_tr_b16 a[66:67], v2 offset:45568
    v_mul_f32 v204, v236, v204
    s_waitcnt lgkmcnt(4)
    v_mfma_f32_32x32x16_bf16 a[12:27], v[108:111], a[44:47], a[12:27]
    ds_read_b64_tr_b16 a[68:69], v1 offset:47104
    ds_read_b64_tr_b16 a[70:71], v1 offset:47616
    v_mul_f32 v205, v237, v205
    v_mul_f32 v206, v238, v206
    v_mfma_f32_32x32x16_bf16 a[28:43], v[108:111], a[48:51], a[28:43]
    ds_read_b64_tr_b16 a[72:73], v2 offset:47104
    ds_read_b64_tr_b16 a[74:75], v2 offset:47616
    v_mul_f32 v207, v239, v207
    v_mfma_f32_32x32x16_bf16 a[12:27], v[112:115], a[52:55], a[12:27]
    ds_read_b64_tr_b16 a[44:45], v1 offset:49152
    ds_read_b64_tr_b16 a[46:47], v1 offset:49664
    v_cvt_pk_bf16_f32 v228, v200, v201
    v_cvt_pk_bf16_f32 v229, v202, v203
    v_mfma_f32_32x32x16_bf16 a[28:43], v[112:115], a[56:59], a[28:43]
    ds_read_b64_tr_b16 a[48:49], v2 offset:49152
    ds_read_b64_tr_b16 a[50:51], v2 offset:49664
    v_cvt_pk_bf16_f32 v230, v204, v205
    s_waitcnt lgkmcnt(4)
    v_mfma_f32_32x32x16_bf16 a[12:27], v[116:119], a[60:63], a[12:27]
    ds_read_b64_tr_b16 a[52:53], v1 offset:51200
    ds_read_b64_tr_b16 a[54:55], v1 offset:51712
    v_cvt_pk_bf16_f32 v231, v206, v207
    v_mfma_f32_32x32x16_bf16 a[28:43], v[116:119], a[64:67], a[28:43]
    ds_read_b64_tr_b16 a[56:57], v2 offset:51200
    ds_read_b64_tr_b16 a[58:59], v2 offset:51712
    buffer_store_dwordx4 v[228:231], v8, s[32:35], s47 offen offset:1024 sc1
    v_mul_f32 v208, v240, v208
    v_mfma_f32_32x32x16_bf16 a[12:27], v[120:123], a[68:71], a[12:27]
    ds_read_b64_tr_b16 a[60:61], v1 offset:53248
    ds_read_b64_tr_b16 a[62:63], v1 offset:53760
    v_mul_f32 v209, v241, v209
    v_mfma_f32_32x32x16_bf16 a[28:43], v[120:123], a[72:75], a[28:43]
    ds_read_b64_tr_b16 a[64:65], v2 offset:53248
    ds_read_b64_tr_b16 a[66:67], v2 offset:53760
    v_mul_f32 v210, v242, v210
    v_mul_f32 v211, v243, v211
    s_waitcnt lgkmcnt(4)
    v_mfma_f32_32x32x16_bf16 a[12:27], v[124:127], a[44:47], a[12:27]
    ds_read_b64_tr_b16 a[68:69], v1 offset:55296
    ds_read_b64_tr_b16 a[70:71], v1 offset:55808
    v_mul_f32 v212, v244, v212
    v_mfma_f32_32x32x16_bf16 a[28:43], v[124:127], a[48:51], a[28:43]
    ds_read_b64_tr_b16 a[72:73], v2 offset:55296
    ds_read_b64_tr_b16 a[74:75], v2 offset:55808
    v_mul_f32 v213, v245, v213
    v_mul_f32 v214, v246, v214
    v_mfma_f32_32x32x16_bf16 a[12:27], v[128:131], a[52:55], a[12:27]
    ds_read_b64_tr_b16 a[44:45], v1 offset:57344
    ds_read_b64_tr_b16 a[46:47], v1 offset:57856
    v_mul_f32 v215, v247, v215
    v_mfma_f32_32x32x16_bf16 a[28:43], v[128:131], a[56:59], a[28:43]
    ds_read_b64_tr_b16 a[48:49], v2 offset:57344
    ds_read_b64_tr_b16 a[50:51], v2 offset:57856
    v_cvt_pk_bf16_f32 v240, v208, v209
    s_waitcnt lgkmcnt(4)
    v_mfma_f32_32x32x16_bf16 a[12:27], v[132:135], a[60:63], a[12:27]
    ds_read_b64_tr_b16 a[52:53], v1 offset:59392
    ds_read_b64_tr_b16 a[54:55], v1 offset:59904
    v_cvt_pk_bf16_f32 v241, v210, v211
    v_cvt_pk_bf16_f32 v242, v212, v213
    v_mfma_f32_32x32x16_bf16 a[28:43], v[132:135], a[64:67], a[28:43]
    ds_read_b64_tr_b16 a[56:57], v2 offset:59392
    ds_read_b64_tr_b16 a[58:59], v2 offset:59904
    v_cvt_pk_bf16_f32 v243, v214, v215
    v_mfma_f32_32x32x16_bf16 a[12:27], v[136:139], a[68:71], a[12:27]
    ds_read_b64_tr_b16 a[60:61], v1 offset:61440
    ds_read_b64_tr_b16 a[62:63], v1 offset:61952
    buffer_store_dwordx4 v[240:243], v8, s[32:35], s47 offen offset:2048 sc1
    v_mul_f32 v216, v248, v216
    v_mfma_f32_32x32x16_bf16 a[28:43], v[136:139], a[72:75], a[28:43]
    ds_read_b64_tr_b16 a[64:65], v2 offset:61440
    ds_read_b64_tr_b16 a[66:67], v2 offset:61952
    v_mul_f32 v217, v249, v217
    s_waitcnt lgkmcnt(4)
    v_mfma_f32_32x32x16_bf16 a[12:27], v[140:143], a[44:47], a[12:27]
    ds_read_b64_tr_b16 a[68:69], v1 offset:63488
    ds_read_b64_tr_b16 a[70:71], v1 offset:64000
    v_mul_f32 v218, v250, v218
    v_mfma_f32_32x32x16_bf16 a[28:43], v[140:143], a[48:51], a[28:43]
    ds_read_b64_tr_b16 a[72:73], v2 offset:63488
    ds_read_b64_tr_b16 a[74:75], v2 offset:64000
    v_mul_f32 v219, v251, v219
    v_mul_f32 v220, v252, v220
    v_mfma_f32_32x32x16_bf16 a[12:27], v[144:147], a[52:55], a[12:27]
    v_add_u32 v1, 0x10000, v1
    v_add_u32 v2, 0x10000, v2
    ds_read_b64_tr_b16 a[44:45], v1 offset:0
    ds_read_b64_tr_b16 a[46:47], v1 offset:512
    v_mul_f32 v221, v253, v221
    v_mfma_f32_32x32x16_bf16 a[28:43], v[144:147], a[56:59], a[28:43]
    ds_read_b64_tr_b16 a[48:49], v2 offset:0
    ds_read_b64_tr_b16 a[50:51], v2 offset:512
    v_mul_f32 v222, v254, v222
    s_waitcnt lgkmcnt(4)
    v_mfma_f32_32x32x16_bf16 a[12:27], v[148:151], a[60:63], a[12:27]
    ds_read_b64_tr_b16 a[52:53], v1 offset:2048
    ds_read_b64_tr_b16 a[54:55], v1 offset:2560
    v_mul_f32 v223, v255, v223
    v_mfma_f32_32x32x16_bf16 a[28:43], v[148:151], a[64:67], a[28:43]
    ds_read_b64_tr_b16 a[56:57], v2 offset:2048
    ds_read_b64_tr_b16 a[58:59], v2 offset:2560
    v_cvt_pk_bf16_f32 v244, v216, v217
    v_cvt_pk_bf16_f32 v245, v218, v219
    v_mfma_f32_32x32x16_bf16 a[12:27], v[152:155], a[68:71], a[12:27]
    ds_read_b64_tr_b16 a[60:61], v1 offset:4096
    ds_read_b64_tr_b16 a[62:63], v1 offset:4608
    v_cvt_pk_bf16_f32 v246, v220, v221
    v_mfma_f32_32x32x16_bf16 a[28:43], v[152:155], a[72:75], a[28:43]
    ds_read_b64_tr_b16 a[64:65], v2 offset:4096
    ds_read_b64_tr_b16 a[66:67], v2 offset:4608
    v_cvt_pk_bf16_f32 v247, v222, v223
    buffer_store_dwordx4 v[244:247], v8, s[32:35], s47 offen offset:3072 sc1
    s_waitcnt lgkmcnt(4)
    v_mfma_f32_32x32x16_bf16 a[12:27], v[156:159], a[44:47], a[12:27]
    ds_read_b64_tr_b16 a[68:69], v1 offset:6144
    ds_read_b64_tr_b16 a[70:71], v1 offset:6656
    v_mfma_f32_32x32x16_bf16 a[28:43], v[156:159], a[48:51], a[28:43]
    ds_read_b64_tr_b16 a[72:73], v2 offset:6144
    ds_read_b64_tr_b16 a[74:75], v2 offset:6656
    v_mfma_f32_32x32x16_bf16 a[12:27], a[0:3], a[52:55], a[12:27]
    v_mfma_f32_32x32x16_bf16 a[28:43], a[0:3], a[56:59], a[28:43]
    s_waitcnt lgkmcnt(0)
    v_mfma_f32_32x32x16_bf16 a[12:27], a[4:7], a[60:63], a[12:27]
    s_waitcnt vmcnt(4)
    s_barrier
    v_add_u32 v1, s46, v1
    v_add_u32 v2, s46, v2
    ds_read_b64_tr_b16 a[44:45], v1 offset:0
    ds_read_b64_tr_b16 a[46:47], v1 offset:512
    ds_read_b64_tr_b16 a[52:53], v1 offset:2048
    ds_read_b64_tr_b16 a[54:55], v1 offset:2560
    v_mfma_f32_32x32x16_bf16 a[28:43], a[4:7], a[64:67], a[28:43]
    ds_read_b64_tr_b16 a[48:49], v2 offset:0
    ds_read_b64_tr_b16 a[50:51], v2 offset:512
    ds_read_b64_tr_b16 a[56:57], v2 offset:2048
    ds_read_b64_tr_b16 a[58:59], v2 offset:2560
    v_mfma_f32_32x32x16_bf16 a[12:27], a[8:11], a[68:71], a[12:27]
    ds_read_b64_tr_b16 a[60:61], v1 offset:4096
    ds_read_b64_tr_b16 a[62:63], v1 offset:4608
    v_mfma_f32_32x32x16_bf16 a[28:43], a[8:11], a[72:75], a[28:43]
    ds_read_b64_tr_b16 a[64:65], v2 offset:4096
    ds_read_b64_tr_b16 a[66:67], v2 offset:4608
    s_add_u32 s55, s41, s43
    s_mul_i32 s49, s55, 264192
    s_add_u32 s56, s49, 132096
    s_mov_b32 s59, 1.0
    s_cmp_lt_u32 s55, 9
    s_cselect_b32 s57, 0x3e274c22, s59
    s_waitcnt lgkmcnt(4)
    v_mfma_f32_32x32x16_bf16 v[160:175], a[44:47], v[28:31], 0
    ds_read_b64_tr_b16 a[68:69], v1 offset:6144
    ds_read_b64_tr_b16 a[70:71], v1 offset:6656
    s_add_u32 s51, s42, s43
    s_mov_b32 s20, s10
    s_mov_b32 s21, s11
    s_mov_b32 s22, 5308416
    v_mfma_f32_32x32x16_bf16 v[176:191], a[48:51], v[28:31], 0
    ds_read_b64_tr_b16 a[72:73], v2 offset:6144
    ds_read_b64_tr_b16 a[74:75], v2 offset:6656
    s_mov_b32 s52, 9216
    s_mul_i32 s44, s36, 221184
    s_lshl_b32 s50, s51, 7
    s_add_u32 s44, s44, s50
    v_mfma_f32_32x32x16_bf16 v[160:175], a[52:55], v[32:35], v[160:175]
    ds_read_b64_tr_b16 a[44:45], v1 offset:8192
    ds_read_b64_tr_b16 a[46:47], v1 offset:8704
    s_mov_b32 s45, 884736
    v_mad_u32_u24 v5, v3, s52, v4
    v_add_u32 v6, 72704, v5
    v_add_u32 v7, 145408, v5
    v_mfma_f32_32x32x16_bf16 v[176:191], a[56:59], v[32:35], v[176:191]
    ds_read_b64_tr_b16 a[48:49], v2 offset:8192
    ds_read_b64_tr_b16 a[50:51], v2 offset:8704
    s_mul_i32 s50, s36, 3072
    s_add_u32 m0, s53, s50
    s_lshl_b32 s50, s53, 1
    s_waitcnt lgkmcnt(4)
    v_mfma_f32_32x32x16_bf16 v[160:175], a[60:63], v[36:39], v[160:175]
    ds_read_b64_tr_b16 a[52:53], v1 offset:10240
    ds_read_b64_tr_b16 a[54:55], v1 offset:10752
    s_sub_u32 s46, s50, 139264
    s_sub_u32 s53, 73728, s53
    v_mfma_f32_32x32x16_bf16 v[176:191], a[64:67], v[36:39], v[176:191]
    ds_read_b64_tr_b16 a[56:57], v2 offset:10240
    ds_read_b64_tr_b16 a[58:59], v2 offset:10752
    buffer_load_dwordx4 v5, s[20:23], s44 offen offset:0 lds
    v_mfma_f32_32x32x16_bf16 v[160:175], a[68:71], v[40:43], v[160:175]
    ds_read_b64_tr_b16 a[60:61], v1 offset:12288
    ds_read_b64_tr_b16 a[62:63], v1 offset:12800
    buffer_load_dwordx4 v6, s[20:23], s44 offen offset:1024 lds
    v_mfma_f32_32x32x16_bf16 v[176:191], a[72:75], v[40:43], v[176:191]
    ds_read_b64_tr_b16 a[64:65], v2 offset:12288
    ds_read_b64_tr_b16 a[66:67], v2 offset:12800
    buffer_load_dwordx4 v7, s[20:23], s44 offen offset:2048 lds
    s_waitcnt lgkmcnt(4)
    v_mfma_f32_32x32x16_bf16 v[160:175], a[44:47], v[44:47], v[160:175]
    ds_read_b64_tr_b16 a[68:69], v1 offset:14336
    ds_read_b64_tr_b16 a[70:71], v1 offset:14848
    s_add_u32 m0, m0, 12288
    v_mfma_f32_32x32x16_bf16 v[176:191], a[48:51], v[44:47], v[176:191]
    ds_read_b64_tr_b16 a[72:73], v2 offset:14336
    ds_read_b64_tr_b16 a[74:75], v2 offset:14848
    s_add_u32 s44, s44, s45
    v_mfma_f32_32x32x16_bf16 v[160:175], a[52:55], v[48:51], v[160:175]
    ds_read_b64_tr_b16 a[44:45], v1 offset:16384
    ds_read_b64_tr_b16 a[46:47], v1 offset:16896
    buffer_load_dwordx4 v5, s[20:23], s44 offen offset:0 lds
    v_mfma_f32_32x32x16_bf16 v[176:191], a[56:59], v[48:51], v[176:191]
    ds_read_b64_tr_b16 a[48:49], v2 offset:16384
    ds_read_b64_tr_b16 a[50:51], v2 offset:16896
    buffer_load_dwordx4 v6, s[20:23], s44 offen offset:1024 lds
    v_accvgpr_read_b32 v12, a80
    s_waitcnt lgkmcnt(4)
    v_mfma_f32_32x32x16_bf16 v[160:175], a[60:63], v[52:55], v[160:175]
    ds_read_b64_tr_b16 a[52:53], v1 offset:18432
    ds_read_b64_tr_b16 a[54:55], v1 offset:18944
    buffer_load_dwordx4 v7, s[20:23], s44 offen offset:2048 lds
    v_accvgpr_read_b32 v13, a81
    v_mul_f32 v224, s57, v12
    v_mfma_f32_32x32x16_bf16 v[176:191], a[64:67], v[52:55], v[176:191]
    ds_read_b64_tr_b16 a[56:57], v2 offset:18432
    ds_read_b64_tr_b16 a[58:59], v2 offset:18944
    s_add_u32 m0, m0, 12288
    v_accvgpr_read_b32 v14, a82
    v_mul_f32 v225, s57, v13
    v_accvgpr_read_b32 v15, a83
    v_mfma_f32_32x32x16_bf16 v[160:175], a[68:71], v[56:59], v[160:175]
    ds_read_b64_tr_b16 a[60:61], v1 offset:20480
    ds_read_b64_tr_b16 a[62:63], v1 offset:20992
    s_add_u32 s44, s44, s45
    v_mul_f32 v226, s57, v14
    v_accvgpr_read_b32 v12, a84
    v_mfma_f32_32x32x16_bf16 v[176:191], a[72:75], v[56:59], v[176:191]
    ds_read_b64_tr_b16 a[64:65], v2 offset:20480
    ds_read_b64_tr_b16 a[66:67], v2 offset:20992
    buffer_load_dwordx4 v5, s[20:23], s44 offen offset:0 lds
    v_mul_f32 v227, s57, v15
    v_accvgpr_read_b32 v13, a85
    s_waitcnt lgkmcnt(4)
    v_mfma_f32_32x32x16_bf16 v[160:175], a[44:47], v[60:63], v[160:175]
    ds_read_b64_tr_b16 a[68:69], v1 offset:22528
    ds_read_b64_tr_b16 a[70:71], v1 offset:23040
    buffer_load_dwordx4 v6, s[20:23], s44 offen offset:1024 lds
    v_mul_f32 v228, s57, v12
    v_accvgpr_read_b32 v14, a86
    v_mfma_f32_32x32x16_bf16 v[176:191], a[48:51], v[60:63], v[176:191]
    ds_read_b64_tr_b16 a[72:73], v2 offset:22528
    ds_read_b64_tr_b16 a[74:75], v2 offset:23040
    buffer_load_dwordx4 v7, s[20:23], s44 offen offset:2048 lds
    v_mul_f32 v229, s57, v13
    v_accvgpr_read_b32 v15, a87
    v_mfma_f32_32x32x16_bf16 v[160:175], a[52:55], v[64:67], v[160:175]
    ds_read_b64_tr_b16 a[44:45], v1 offset:24576
    ds_read_b64_tr_b16 a[46:47], v1 offset:25088
    s_add_u32 m0, m0, 12288
    v_mul_f32 v230, s57, v14
    v_accvgpr_read_b32 v12, a88
    v_mul_f32 v231, s57, v15
    v_mfma_f32_32x32x16_bf16 v[176:191], a[56:59], v[64:67], v[176:191]
    ds_read_b64_tr_b16 a[48:49], v2 offset:24576
    ds_read_b64_tr_b16 a[50:51], v2 offset:25088
    s_add_u32 s44, s44, s45
    v_accvgpr_read_b32 v13, a89
    s_waitcnt lgkmcnt(4)
    v_mfma_f32_32x32x16_bf16 v[160:175], a[60:63], v[68:71], v[160:175]
    ds_read_b64_tr_b16 a[52:53], v1 offset:26624
    ds_read_b64_tr_b16 a[54:55], v1 offset:27136
    buffer_load_dwordx4 v5, s[20:23], s44 offen offset:0 lds
    v_mul_f32 v232, s57, v12
    v_accvgpr_read_b32 v14, a90
    v_mul_f32 v233, s57, v13
    v_mfma_f32_32x32x16_bf16 v[176:191], a[64:67], v[68:71], v[176:191]
    ds_read_b64_tr_b16 a[56:57], v2 offset:26624
    ds_read_b64_tr_b16 a[58:59], v2 offset:27136
    buffer_load_dwordx4 v6, s[20:23], s44 offen offset:1024 lds
    v_accvgpr_read_b32 v15, a91
    v_mul_f32 v234, s57, v14
    v_mfma_f32_32x32x16_bf16 v[160:175], a[68:71], v[72:75], v[160:175]
    ds_read_b64_tr_b16 a[60:61], v1 offset:28672
    ds_read_b64_tr_b16 a[62:63], v1 offset:29184
    buffer_load_dwordx4 v7, s[20:23], s44 offen offset:2048 lds
    v_accvgpr_read_b32 v12, a92
    v_mul_f32 v235, s57, v15
    v_accvgpr_read_b32 v13, a93
    v_mfma_f32_32x32x16_bf16 v[176:191], a[72:75], v[72:75], v[176:191]
    ds_read_b64_tr_b16 a[64:65], v2 offset:28672
    ds_read_b64_tr_b16 a[66:67], v2 offset:29184
    s_add_u32 m0, m0, 12288
    v_mul_f32 v236, s57, v12
    s_waitcnt lgkmcnt(4)
    v_mfma_f32_32x32x16_bf16 v[160:175], a[44:47], v[76:79], v[160:175]
    ds_read_b64_tr_b16 a[68:69], v1 offset:30720
    ds_read_b64_tr_b16 a[70:71], v1 offset:31232
    s_add_u32 s44, s44, s45
    v_accvgpr_read_b32 v14, a94
    v_mul_f32 v237, s57, v13
    v_mfma_f32_32x32x16_bf16 v[176:191], a[48:51], v[76:79], v[176:191]
    ds_read_b64_tr_b16 a[72:73], v2 offset:30720
    ds_read_b64_tr_b16 a[74:75], v2 offset:31232
    buffer_load_dwordx4 v5, s[20:23], s44 offen offset:0 lds
    v_accvgpr_read_b32 v15, a95
    v_mul_f32 v238, s57, v14
    v_mul_f32 v239, s57, v15
    v_mfma_f32_32x32x16_bf16 v[160:175], a[52:55], v[80:83], v[160:175]
    ds_read_b64_tr_b16 a[44:45], v1 offset:32768
    ds_read_b64_tr_b16 a[46:47], v1 offset:33280
    buffer_load_dwordx4 v6, s[20:23], s44 offen offset:1024 lds
    v_accvgpr_read_b32 v12, a12
    v_accvgpr_read_b32 v13, a13
    v_mfma_f32_32x32x16_bf16 v[176:191], a[56:59], v[80:83], v[176:191]
    ds_read_b64_tr_b16 a[48:49], v2 offset:32768
    ds_read_b64_tr_b16 a[50:51], v2 offset:33280
    buffer_load_dwordx4 v7, s[20:23], s44 offen offset:2048 lds
    v_mul_f32 v12, v12, v224
    v_mul_f32 v13, v13, v225
    s_waitcnt lgkmcnt(4)
    v_mfma_f32_32x32x16_bf16 v[160:175], a[60:63], v[84:87], v[160:175]
    ds_read_b64_tr_b16 a[52:53], v1 offset:34816
    ds_read_b64_tr_b16 a[54:55], v1 offset:35328
    s_add_u32 m0, m0, 12288
    v_cvt_pk_bf16_f32 v16, v12, v13
    v_accvgpr_read_b32 v14, a14
    v_mfma_f32_32x32x16_bf16 v[176:191], a[64:67], v[84:87], v[176:191]
    ds_read_b64_tr_b16 a[56:57], v2 offset:34816
    ds_read_b64_tr_b16 a[58:59], v2 offset:35328
    s_add_u32 s44, s44, s45
    v_accvgpr_read_b32 v15, a15
    v_mul_f32 v14, v14, v226
    v_mfma_f32_32x32x16_bf16 v[160:175], a[68:71], v[88:91], v[160:175]
    ds_read_b64_tr_b16 a[60:61], v1 offset:36864
    ds_read_b64_tr_b16 a[62:63], v1 offset:37376
    buffer_load_dwordx4 v5, s[20:23], s44 offen offset:0 lds
    v_mul_f32 v15, v15, v227
    v_cvt_pk_bf16_f32 v17, v14, v15
    v_accvgpr_read_b32 v12, a16
    v_mfma_f32_32x32x16_bf16 v[176:191], a[72:75], v[88:91], v[176:191]
    ds_read_b64_tr_b16 a[64:65], v2 offset:36864
    ds_read_b64_tr_b16 a[66:67], v2 offset:37376
    buffer_load_dwordx4 v6, s[20:23], s44 offen offset:1024 lds
    v_accvgpr_read_b32 v13, a17
    s_waitcnt lgkmcnt(4)
    v_mfma_f32_32x32x16_bf16 v[160:175], a[44:47], v[92:95], v[160:175]
    ds_read_b64_tr_b16 a[68:69], v1 offset:38912
    ds_read_b64_tr_b16 a[70:71], v1 offset:39424
    buffer_load_dwordx4 v7, s[20:23], s44 offen offset:2048 lds
    v_mul_f32 v12, v12, v228
    v_mul_f32 v13, v13, v229
    v_cvt_pk_bf16_f32 v18, v12, v13
    v_mfma_f32_32x32x16_bf16 v[176:191], a[48:51], v[92:95], v[176:191]
    ds_read_b64_tr_b16 a[72:73], v2 offset:38912
    ds_read_b64_tr_b16 a[74:75], v2 offset:39424
    s_add_u32 m0, m0, 12288
    v_accvgpr_read_b32 v14, a18
    v_accvgpr_read_b32 v15, a19
    v_mfma_f32_32x32x16_bf16 v[160:175], a[52:55], v[96:99], v[160:175]
    ds_read_b64_tr_b16 a[44:45], v1 offset:40960
    ds_read_b64_tr_b16 a[46:47], v1 offset:41472
    s_add_u32 s44, s44, s45
    v_mul_f32 v14, v14, v230
    v_mul_f32 v15, v15, v231
    v_cvt_pk_bf16_f32 v19, v14, v15
    v_mfma_f32_32x32x16_bf16 v[176:191], a[56:59], v[96:99], v[176:191]
    ds_read_b64_tr_b16 a[48:49], v2 offset:40960
    ds_read_b64_tr_b16 a[50:51], v2 offset:41472
    s_add_u32 s58, s43, 2
    s_cmp_lt_u32 s58, s39
    s_cselect_b32 s51, 1, 0
    s_waitcnt lgkmcnt(4)
    v_mfma_f32_32x32x16_bf16 v[160:175], a[60:63], v[100:103], v[160:175]
    ds_read_b64_tr_b16 a[52:53], v1 offset:43008
    ds_read_b64_tr_b16 a[54:55], v1 offset:43520
    s_add_u32 s55, s41, s58
    s_mov_b32 s60, s6
    s_mov_b32 s61, s7
    s_mul_i32 s62, s51, 1990656
    v_mfma_f32_32x32x16_bf16 v[176:191], a[64:67], v[100:103], v[176:191]
    ds_read_b64_tr_b16 a[56:57], v2 offset:43008
    ds_read_b64_tr_b16 a[58:59], v2 offset:43520
    v_accvgpr_read_b32 v24, a76
    s_lshl_b32 s59, s55, 7
    v_mul_u32_u24 v24, 3456, v24
    buffer_load_dword a77, v24, s[60:63], s59 offen
    v_mfma_f32_32x32x16_bf16 v[160:175], a[68:71], v[104:107], v[160:175]
    ds_read_b64_tr_b16 a[60:61], v1 offset:45056
    ds_read_b64_tr_b16 a[62:63], v1 offset:45568
    s_cmp_lt_u32 s58, s40
    s_cselect_b32 s51, 1, 0
    s_add_u32 s55, s42, s58
    s_mov_b32 s60, s8
    v_mfma_f32_32x32x16_bf16 v[176:191], a[72:75], v[104:107], v[176:191]
    ds_read_b64_tr_b16 a[64:65], v2 offset:45056
    ds_read_b64_tr_b16 a[66:67], v2 offset:45568
    s_mov_b32 s61, s9
    s_mul_i32 s62, s51, 5308416
    v_accvgpr_read_b32 v24, a76
    buffer_store_dwordx4 v[16:19], v9, s[24:27], s49 offen offset:0 sc1
    s_waitcnt lgkmcnt(4)
    v_mfma_f32_32x32x16_bf16 v[160:175], a[44:47], v[108:111], v[160:175]
    ds_read_b64_tr_b16 a[68:69], v1 offset:47104
    ds_read_b64_tr_b16 a[70:71], v1 offset:47616
    s_lshl_b32 s59, s55, 7
    v_mul_u32_u24 v24, 9216, v24
    buffer_load_dword a77, v24, s[60:63], s59 offen
    s_mov_b32 s60, s10
    v_mfma_f32_32x32x16_bf16 v[176:191], a[48:51], v[108:111], v[176:191]
    ds_read_b64_tr_b16 a[72:73], v2 offset:47104
    ds_read_b64_tr_b16 a[74:75], v2 offset:47616
    s_mov_b32 s61, s11
    s_mul_i32 s62, s51, 5308416
    v_accvgpr_read_b32 v24, a76
    s_lshl_b32 s59, s55, 7
    v_mfma_f32_32x32x16_bf16 v[160:175], a[52:55], v[112:115], v[160:175]
    ds_read_b64_tr_b16 a[44:45], v1 offset:49152
    ds_read_b64_tr_b16 a[46:47], v1 offset:49664
    v_mul_u32_u24 v24, 9216, v24
    buffer_load_dword a77, v24, s[60:63], s59 offen
    s_add_u32 s58, s43, 1
    s_cmp_lt_u32 s58, s39
    v_mfma_f32_32x32x16_bf16 v[176:191], a[56:59], v[112:115], v[176:191]
    ds_read_b64_tr_b16 a[48:49], v2 offset:49152
    ds_read_b64_tr_b16 a[50:51], v2 offset:49664
    s_cselect_b32 s16, s6, s8
    s_cselect_b32 s17, s7, s9
    s_cselect_b32 s51, s41, s42
    v_accvgpr_read_b32 v12, a20
    s_waitcnt lgkmcnt(4)
    v_mfma_f32_32x32x16_bf16 v[160:175], a[60:63], v[116:119], v[160:175]
    ds_read_b64_tr_b16 a[52:53], v1 offset:51200
    ds_read_b64_tr_b16 a[54:55], v1 offset:51712
    s_mov_b32 s59, 9216
    s_cselect_b32 s30, 3456, s59
    s_add_u32 s51, s51, s58
    s_mul_i32 s18, s30, 576
    v_mfma_f32_32x32x16_bf16 v[176:191], a[64:67], v[116:119], v[176:191]
    ds_read_b64_tr_b16 a[56:57], v2 offset:51200
    ds_read_b64_tr_b16 a[58:59], v2 offset:51712
    s_cmp_lt_u32 s58, s40
    s_cselect_b32 s18, s18, 0
    s_mul_i32 s28, s36, s30
    s_mul_i32 s28, s28, 24
    v_mfma_f32_32x32x16_bf16 v[160:175], a[68:71], v[120:123], v[160:175]
    ds_read_b64_tr_b16 a[60:61], v1 offset:53248
    ds_read_b64_tr_b16 a[62:63], v1 offset:53760
    s_lshl_b32 s50, s51, 7
    s_add_u32 s28, s28, s50
    s_mul_i32 s29, s30, 96
    v_mad_u32_u24 v5, v3, s30, v4
    v_mfma_f32_32x32x16_bf16 v[176:191], a[72:75], v[120:123], v[176:191]
    ds_read_b64_tr_b16 a[64:65], v2 offset:53248
    ds_read_b64_tr_b16 a[66:67], v2 offset:53760
    s_lshl_b32 s50, s30, 3
    s_sub_u32 s50, s50, 1024
    v_add_u32 v6, s50, v5
    v_accvgpr_read_b32 v13, a21
    s_waitcnt lgkmcnt(4)
    v_mfma_f32_32x32x16_bf16 v[160:175], a[44:47], v[124:127], v[160:175]
    ds_read_b64_tr_b16 a[68:69], v1 offset:55296
    ds_read_b64_tr_b16 a[70:71], v1 offset:55808
    v_add_u32 v7, s50, v6
    v_mul_f32 v12, v12, v232
    v_mul_f32 v13, v13, v233
    v_cvt_pk_bf16_f32 v20, v12, v13
    v_mfma_f32_32x32x16_bf16 v[176:191], a[48:51], v[124:127], v[176:191]
    ds_read_b64_tr_b16 a[72:73], v2 offset:55296
    ds_read_b64_tr_b16 a[74:75], v2 offset:55808
    v_accvgpr_read_b32 v14, a22
    v_accvgpr_read_b32 v15, a23
    v_mul_f32 v14, v14, v234
    v_mul_f32 v15, v15, v235
    v_mfma_f32_32x32x16_bf16 v[160:175], a[52:55], v[128:131], v[160:175]
    ds_read_b64_tr_b16 a[44:45], v1 offset:57344
    ds_read_b64_tr_b16 a[46:47], v1 offset:57856
    v_cvt_pk_bf16_f32 v21, v14, v15
    v_accvgpr_read_b32 v12, a24
    v_accvgpr_read_b32 v13, a25
    v_mul_f32 v12, v12, v236
    v_mfma_f32_32x32x16_bf16 v[176:191], a[56:59], v[128:131], v[176:191]
    ds_read_b64_tr_b16 a[48:49], v2 offset:57344
    ds_read_b64_tr_b16 a[50:51], v2 offset:57856
    v_mul_f32 v13, v13, v237
    v_cvt_pk_bf16_f32 v22, v12, v13
    v_accvgpr_read_b32 v14, a26
    v_accvgpr_read_b32 v15, a27
    s_waitcnt lgkmcnt(4)
    v_mfma_f32_32x32x16_bf16 v[160:175], a[60:63], v[132:135], v[160:175]
    ds_read_b64_tr_b16 a[52:53], v1 offset:59392
    ds_read_b64_tr_b16 a[54:55], v1 offset:59904
    v_mul_f32 v14, v14, v238
    v_mul_f32 v15, v15, v239
    v_cvt_pk_bf16_f32 v23, v14, v15
    buffer_store_dwordx4 v[20:23], v9, s[24:27], s49 offen offset:128 sc1
    v_mfma_f32_32x32x16_bf16 v[176:191], a[64:67], v[132:135], v[176:191]
    ds_read_b64_tr_b16 a[56:57], v2 offset:59392
    ds_read_b64_tr_b16 a[58:59], v2 offset:59904
    v_accvgpr_read_b32 v12, a28
    v_accvgpr_read_b32 v13, a29
    v_mul_f32 v12, v12, v224
    v_mul_f32 v13, v13, v225
    v_mfma_f32_32x32x16_bf16 v[160:175], a[68:71], v[136:139], v[160:175]
    ds_read_b64_tr_b16 a[60:61], v1 offset:61440
    ds_read_b64_tr_b16 a[62:63], v1 offset:61952
    v_cvt_pk_bf16_f32 v16, v12, v13
    v_accvgpr_read_b32 v14, a30
    v_accvgpr_read_b32 v15, a31
    v_mul_f32 v14, v14, v226
    v_mfma_f32_32x32x16_bf16 v[176:191], a[72:75], v[136:139], v[176:191]
    ds_read_b64_tr_b16 a[64:65], v2 offset:61440
    ds_read_b64_tr_b16 a[66:67], v2 offset:61952
    v_mul_f32 v15, v15, v227
    v_cvt_pk_bf16_f32 v17, v14, v15
    v_accvgpr_read_b32 v12, a32
    v_accvgpr_read_b32 v13, a33
    s_waitcnt lgkmcnt(4)
    v_mfma_f32_32x32x16_bf16 v[160:175], a[44:47], v[140:143], v[160:175]
    ds_read_b64_tr_b16 a[68:69], v1 offset:63488
    ds_read_b64_tr_b16 a[70:71], v1 offset:64000
    v_mul_f32 v12, v12, v228
    v_mul_f32 v13, v13, v229
    v_cvt_pk_bf16_f32 v18, v12, v13
    v_accvgpr_read_b32 v14, a34
    v_mfma_f32_32x32x16_bf16 v[176:191], a[48:51], v[140:143], v[176:191]
    ds_read_b64_tr_b16 a[72:73], v2 offset:63488
    ds_read_b64_tr_b16 a[74:75], v2 offset:64000
    v_accvgpr_read_b32 v15, a35
    v_mul_f32 v14, v14, v230
    v_mul_f32 v15, v15, v231
    v_cvt_pk_bf16_f32 v19, v14, v15
    v_mfma_f32_32x32x16_bf16 v[160:175], a[52:55], v[144:147], v[160:175]
    v_add_u32 v1, 0x10000, v1
    v_add_u32 v2, 0x10000, v2
    ds_read_b64_tr_b16 a[44:45], v1 offset:0
    ds_read_b64_tr_b16 a[46:47], v1 offset:512
    buffer_store_dwordx4 v[16:19], v9, s[24:27], s56 offen offset:0 sc1
    v_accvgpr_read_b32 v12, a36
    v_mfma_f32_32x32x16_bf16 v[176:191], a[56:59], v[144:147], v[176:191]
    ds_read_b64_tr_b16 a[48:49], v2 offset:0
    ds_read_b64_tr_b16 a[50:51], v2 offset:512
    v_accvgpr_read_b32 v13, a37
    v_mul_f32 v12, v12, v232
    v_mul_f32 v13, v13, v233
    v_cvt_pk_bf16_f32 v20, v12, v13
    s_waitcnt lgkmcnt(4)
    v_mfma_f32_32x32x16_bf16 v[160:175], a[60:63], v[148:151], v[160:175]
    ds_read_b64_tr_b16 a[52:53], v1 offset:2048
    ds_read_b64_tr_b16 a[54:55], v1 offset:2560
    v_accvgpr_read_b32 v14, a38
    v_accvgpr_read_b32 v15, a39
    v_mul_f32 v14, v14, v234
    v_mul_f32 v15, v15, v235
    v_mfma_f32_32x32x16_bf16 v[176:191], a[64:67], v[148:151], v[176:191]
    ds_read_b64_tr_b16 a[56:57], v2 offset:2048
    ds_read_b64_tr_b16 a[58:59], v2 offset:2560
    v_cvt_pk_bf16_f32 v21, v14, v15
    v_accvgpr_read_b32 v12, a40
    v_accvgpr_read_b32 v13, a41
    v_mul_f32 v12, v12, v236
    v_mfma_f32_32x32x16_bf16 v[160:175], a[68:71], v[152:155], v[160:175]
    ds_read_b64_tr_b16 a[60:61], v1 offset:4096
    ds_read_b64_tr_b16 a[62:63], v1 offset:4608
    v_mul_f32 v13, v13, v237
    v_cvt_pk_bf16_f32 v22, v12, v13
    v_accvgpr_read_b32 v14, a42
    v_accvgpr_read_b32 v15, a43
    v_mfma_f32_32x32x16_bf16 v[176:191], a[72:75], v[152:155], v[176:191]
    ds_read_b64_tr_b16 a[64:65], v2 offset:4096
    ds_read_b64_tr_b16 a[66:67], v2 offset:4608
    v_mul_f32 v14, v14, v238
    v_mul_f32 v15, v15, v239
    v_cvt_pk_bf16_f32 v23, v14, v15
    buffer_store_dwordx4 v[20:23], v9, s[24:27], s56 offen offset:128 sc1
    s_waitcnt lgkmcnt(4)
    v_mfma_f32_32x32x16_bf16 v[160:175], a[44:47], v[156:159], v[160:175]
    ds_read_b64_tr_b16 a[68:69], v1 offset:6144
    ds_read_b64_tr_b16 a[70:71], v1 offset:6656
    v_mfma_f32_32x32x16_bf16 v[176:191], a[48:51], v[156:159], v[176:191]
    ds_read_b64_tr_b16 a[72:73], v2 offset:6144
    ds_read_b64_tr_b16 a[74:75], v2 offset:6656
    v_mfma_f32_32x32x16_bf16 v[160:175], a[52:55], a[0:3], v[160:175]
    v_mfma_f32_32x32x16_bf16 v[176:191], a[56:59], a[0:3], v[176:191]
    s_waitcnt lgkmcnt(0)
    v_mfma_f32_32x32x16_bf16 v[160:175], a[60:63], a[4:7], v[160:175]
    s_waitcnt vmcnt(7)
    s_barrier
    v_add_u32 v1, s46, v1
    v_add_u32 v2, s46, v2
    ds_read_b64_tr_b16 a[44:45], v1 offset:0
    ds_read_b64_tr_b16 a[46:47], v1 offset:512
    ds_read_b64_tr_b16 a[52:53], v1 offset:2048
    ds_read_b64_tr_b16 a[54:55], v1 offset:2560
    v_mfma_f32_32x32x16_bf16 v[176:191], a[64:67], a[4:7], v[176:191]
    ds_read_b64_tr_b16 a[48:49], v2 offset:0
    ds_read_b64_tr_b16 a[50:51], v2 offset:512
    ds_read_b64_tr_b16 a[56:57], v2 offset:2048
    ds_read_b64_tr_b16 a[58:59], v2 offset:2560
    v_mfma_f32_32x32x16_bf16 v[160:175], a[68:71], a[8:11], v[160:175]
    ds_read_b64_tr_b16 a[60:61], v1 offset:4096
    ds_read_b64_tr_b16 a[62:63], v1 offset:4608
    v_mfma_f32_32x32x16_bf16 v[176:191], a[72:75], a[8:11], v[176:191]
    ds_read_b64_tr_b16 a[64:65], v2 offset:4096
    ds_read_b64_tr_b16 a[66:67], v2 offset:4608
    s_branch K1_UP
K1_NOQ:
    s_waitcnt lgkmcnt(4)
    v_mfma_f32_32x32x16_bf16 v[160:175], a[44:47], v[28:31], 0
    ds_read_b64_tr_b16 a[68:69], v1 offset:6144
    ds_read_b64_tr_b16 a[70:71], v1 offset:6656
    s_add_u32 s51, s42, s43
    s_mov_b32 s20, s10
    s_mov_b32 s21, s11
    s_mov_b32 s22, 5308416
    v_mfma_f32_32x32x16_bf16 v[176:191], a[48:51], v[28:31], 0
    ds_read_b64_tr_b16 a[72:73], v2 offset:6144
    ds_read_b64_tr_b16 a[74:75], v2 offset:6656
    s_mov_b32 s52, 9216
    s_mul_i32 s44, s36, 221184
    s_lshl_b32 s50, s51, 7
    s_add_u32 s44, s44, s50
    v_mfma_f32_32x32x16_bf16 v[160:175], a[52:55], v[32:35], v[160:175]
    ds_read_b64_tr_b16 a[44:45], v1 offset:8192
    ds_read_b64_tr_b16 a[46:47], v1 offset:8704
    s_mov_b32 s45, 884736
    v_mad_u32_u24 v5, v3, s52, v4
    v_add_u32 v6, 72704, v5
    v_add_u32 v7, 145408, v5
    v_mfma_f32_32x32x16_bf16 v[176:191], a[56:59], v[32:35], v[176:191]
    ds_read_b64_tr_b16 a[48:49], v2 offset:8192
    ds_read_b64_tr_b16 a[50:51], v2 offset:8704
    s_mul_i32 s50, s36, 3072
    s_add_u32 m0, s53, s50
    s_lshl_b32 s50, s53, 1
    s_waitcnt lgkmcnt(4)
    v_mfma_f32_32x32x16_bf16 v[160:175], a[60:63], v[36:39], v[160:175]
    ds_read_b64_tr_b16 a[52:53], v1 offset:10240
    ds_read_b64_tr_b16 a[54:55], v1 offset:10752
    s_sub_u32 s46, s50, 139264
    s_sub_u32 s53, 73728, s53
    v_mfma_f32_32x32x16_bf16 v[176:191], a[64:67], v[36:39], v[176:191]
    ds_read_b64_tr_b16 a[56:57], v2 offset:10240
    ds_read_b64_tr_b16 a[58:59], v2 offset:10752
    buffer_load_dwordx4 v5, s[20:23], s44 offen offset:0 lds
    v_mfma_f32_32x32x16_bf16 v[160:175], a[68:71], v[40:43], v[160:175]
    ds_read_b64_tr_b16 a[60:61], v1 offset:12288
    ds_read_b64_tr_b16 a[62:63], v1 offset:12800
    buffer_load_dwordx4 v6, s[20:23], s44 offen offset:1024 lds
    v_mfma_f32_32x32x16_bf16 v[176:191], a[72:75], v[40:43], v[176:191]
    ds_read_b64_tr_b16 a[64:65], v2 offset:12288
    ds_read_b64_tr_b16 a[66:67], v2 offset:12800
    buffer_load_dwordx4 v7, s[20:23], s44 offen offset:2048 lds
    s_waitcnt lgkmcnt(4)
    v_mfma_f32_32x32x16_bf16 v[160:175], a[44:47], v[44:47], v[160:175]
    ds_read_b64_tr_b16 a[68:69], v1 offset:14336
    ds_read_b64_tr_b16 a[70:71], v1 offset:14848
    s_add_u32 m0, m0, 12288
    v_mfma_f32_32x32x16_bf16 v[176:191], a[48:51], v[44:47], v[176:191]
    ds_read_b64_tr_b16 a[72:73], v2 offset:14336
    ds_read_b64_tr_b16 a[74:75], v2 offset:14848
    s_add_u32 s44, s44, s45
    v_mfma_f32_32x32x16_bf16 v[160:175], a[52:55], v[48:51], v[160:175]
    ds_read_b64_tr_b16 a[44:45], v1 offset:16384
    ds_read_b64_tr_b16 a[46:47], v1 offset:16896
    buffer_load_dwordx4 v5, s[20:23], s44 offen offset:0 lds
    v_mfma_f32_32x32x16_bf16 v[176:191], a[56:59], v[48:51], v[176:191]
    ds_read_b64_tr_b16 a[48:49], v2 offset:16384
    ds_read_b64_tr_b16 a[50:51], v2 offset:16896
    buffer_load_dwordx4 v6, s[20:23], s44 offen offset:1024 lds
    s_waitcnt lgkmcnt(4)
    v_mfma_f32_32x32x16_bf16 v[160:175], a[60:63], v[52:55], v[160:175]
    ds_read_b64_tr_b16 a[52:53], v1 offset:18432
    ds_read_b64_tr_b16 a[54:55], v1 offset:18944
    buffer_load_dwordx4 v7, s[20:23], s44 offen offset:2048 lds
    v_mfma_f32_32x32x16_bf16 v[176:191], a[64:67], v[52:55], v[176:191]
    ds_read_b64_tr_b16 a[56:57], v2 offset:18432
    ds_read_b64_tr_b16 a[58:59], v2 offset:18944
    s_add_u32 m0, m0, 12288
    v_mfma_f32_32x32x16_bf16 v[160:175], a[68:71], v[56:59], v[160:175]
    ds_read_b64_tr_b16 a[60:61], v1 offset:20480
    ds_read_b64_tr_b16 a[62:63], v1 offset:20992
    s_add_u32 s44, s44, s45
    v_mfma_f32_32x32x16_bf16 v[176:191], a[72:75], v[56:59], v[176:191]
    ds_read_b64_tr_b16 a[64:65], v2 offset:20480
    ds_read_b64_tr_b16 a[66:67], v2 offset:20992
    buffer_load_dwordx4 v5, s[20:23], s44 offen offset:0 lds
    s_waitcnt lgkmcnt(4)
    v_mfma_f32_32x32x16_bf16 v[160:175], a[44:47], v[60:63], v[160:175]
    ds_read_b64_tr_b16 a[68:69], v1 offset:22528
    ds_read_b64_tr_b16 a[70:71], v1 offset:23040
    buffer_load_dwordx4 v6, s[20:23], s44 offen offset:1024 lds
    v_mfma_f32_32x32x16_bf16 v[176:191], a[48:51], v[60:63], v[176:191]
    ds_read_b64_tr_b16 a[72:73], v2 offset:22528
    ds_read_b64_tr_b16 a[74:75], v2 offset:23040
    buffer_load_dwordx4 v7, s[20:23], s44 offen offset:2048 lds
    v_mfma_f32_32x32x16_bf16 v[160:175], a[52:55], v[64:67], v[160:175]
    ds_read_b64_tr_b16 a[44:45], v1 offset:24576
    ds_read_b64_tr_b16 a[46:47], v1 offset:25088
    s_add_u32 m0, m0, 12288
    v_mfma_f32_32x32x16_bf16 v[176:191], a[56:59], v[64:67], v[176:191]
    ds_read_b64_tr_b16 a[48:49], v2 offset:24576
    ds_read_b64_tr_b16 a[50:51], v2 offset:25088
    s_add_u32 s44, s44, s45
    s_waitcnt lgkmcnt(4)
    v_mfma_f32_32x32x16_bf16 v[160:175], a[60:63], v[68:71], v[160:175]
    ds_read_b64_tr_b16 a[52:53], v1 offset:26624
    ds_read_b64_tr_b16 a[54:55], v1 offset:27136
    buffer_load_dwordx4 v5, s[20:23], s44 offen offset:0 lds
    v_mfma_f32_32x32x16_bf16 v[176:191], a[64:67], v[68:71], v[176:191]
    ds_read_b64_tr_b16 a[56:57], v2 offset:26624
    ds_read_b64_tr_b16 a[58:59], v2 offset:27136
    buffer_load_dwordx4 v6, s[20:23], s44 offen offset:1024 lds
    v_mfma_f32_32x32x16_bf16 v[160:175], a[68:71], v[72:75], v[160:175]
    ds_read_b64_tr_b16 a[60:61], v1 offset:28672
    ds_read_b64_tr_b16 a[62:63], v1 offset:29184
    buffer_load_dwordx4 v7, s[20:23], s44 offen offset:2048 lds
    v_mfma_f32_32x32x16_bf16 v[176:191], a[72:75], v[72:75], v[176:191]
    ds_read_b64_tr_b16 a[64:65], v2 offset:28672
    ds_read_b64_tr_b16 a[66:67], v2 offset:29184
    s_add_u32 m0, m0, 12288
    s_waitcnt lgkmcnt(4)
    v_mfma_f32_32x32x16_bf16 v[160:175], a[44:47], v[76:79], v[160:175]
    ds_read_b64_tr_b16 a[68:69], v1 offset:30720
    ds_read_b64_tr_b16 a[70:71], v1 offset:31232
    s_add_u32 s44, s44, s45
    v_mfma_f32_32x32x16_bf16 v[176:191], a[48:51], v[76:79], v[176:191]
    ds_read_b64_tr_b16 a[72:73], v2 offset:30720
    ds_read_b64_tr_b16 a[74:75], v2 offset:31232
    buffer_load_dwordx4 v5, s[20:23], s44 offen offset:0 lds
    v_mfma_f32_32x32x16_bf16 v[160:175], a[52:55], v[80:83], v[160:175]
    ds_read_b64_tr_b16 a[44:45], v1 offset:32768
    ds_read_b64_tr_b16 a[46:47], v1 offset:33280
    buffer_load_dwordx4 v6, s[20:23], s44 offen offset:1024 lds
    v_mul_f32 v192, v224, v192
    v_mfma_f32_32x32x16_bf16 v[176:191], a[56:59], v[80:83], v[176:191]
    ds_read_b64_tr_b16 a[48:49], v2 offset:32768
    ds_read_b64_tr_b16 a[50:51], v2 offset:33280
    buffer_load_dwordx4 v7, s[20:23], s44 offen offset:2048 lds
    v_mul_f32 v193, v225, v193
    s_waitcnt lgkmcnt(4)
    v_mfma_f32_32x32x16_bf16 v[160:175], a[60:63], v[84:87], v[160:175]
    ds_read_b64_tr_b16 a[52:53], v1 offset:34816
    ds_read_b64_tr_b16 a[54:55], v1 offset:35328
    s_add_u32 m0, m0, 12288
    v_mul_f32 v194, v226, v194
    v_mfma_f32_32x32x16_bf16 v[176:191], a[64:67], v[84:87], v[176:191]
    ds_read_b64_tr_b16 a[56:57], v2 offset:34816
    ds_read_b64_tr_b16 a[58:59], v2 offset:35328
    s_add_u32 s44, s44, s45
    v_mul_f32 v195, v227, v195
    v_mul_f32 v196, v228, v196
    v_mfma_f32_32x32x16_bf16 v[160:175], a[68:71], v[88:91], v[160:175]
    ds_read_b64_tr_b16 a[60:61], v1 offset:36864
    ds_read_b64_tr_b16 a[62:63], v1 offset:37376
    buffer_load_dwordx4 v5, s[20:23], s44 offen offset:0 lds
    v_mul_f32 v197, v229, v197
    v_mfma_f32_32x32x16_bf16 v[176:191], a[72:75], v[88:91], v[176:191]
    ds_read_b64_tr_b16 a[64:65], v2 offset:36864
    ds_read_b64_tr_b16 a[66:67], v2 offset:37376
    buffer_load_dwordx4 v6, s[20:23], s44 offen offset:1024 lds
    v_mul_f32 v198, v230, v198
    s_waitcnt lgkmcnt(4)
    v_mfma_f32_32x32x16_bf16 v[160:175], a[44:47], v[92:95], v[160:175]
    ds_read_b64_tr_b16 a[68:69], v1 offset:38912
    ds_read_b64_tr_b16 a[70:71], v1 offset:39424
    buffer_load_dwordx4 v7, s[20:23], s44 offen offset:2048 lds
    v_mul_f32 v199, v231, v199
    v_cvt_pk_bf16_f32 v224, v192, v193
    v_mfma_f32_32x32x16_bf16 v[176:191], a[48:51], v[92:95], v[176:191]
    ds_read_b64_tr_b16 a[72:73], v2 offset:38912
    ds_read_b64_tr_b16 a[74:75], v2 offset:39424
    s_add_u32 m0, m0, 12288
    v_cvt_pk_bf16_f32 v225, v194, v195
    v_mfma_f32_32x32x16_bf16 v[160:175], a[52:55], v[96:99], v[160:175]
    ds_read_b64_tr_b16 a[44:45], v1 offset:40960
    ds_read_b64_tr_b16 a[46:47], v1 offset:41472
    s_add_u32 s44, s44, s45
    v_cvt_pk_bf16_f32 v226, v196, v197
    v_cvt_pk_bf16_f32 v227, v198, v199
    v_mfma_f32_32x32x16_bf16 v[176:191], a[56:59], v[96:99], v[176:191]
    ds_read_b64_tr_b16 a[48:49], v2 offset:40960
    ds_read_b64_tr_b16 a[50:51], v2 offset:41472
    s_add_u32 s58, s43, 2
    s_cmp_lt_u32 s58, s39
    s_cselect_b32 s51, 1, 0
    s_waitcnt lgkmcnt(4)
    v_mfma_f32_32x32x16_bf16 v[160:175], a[60:63], v[100:103], v[160:175]
    ds_read_b64_tr_b16 a[52:53], v1 offset:43008
    ds_read_b64_tr_b16 a[54:55], v1 offset:43520
    s_add_u32 s55, s41, s58
    s_mov_b32 s60, s6
    s_mov_b32 s61, s7
    s_mul_i32 s62, s51, 1990656
    v_mfma_f32_32x32x16_bf16 v[176:191], a[64:67], v[100:103], v[176:191]
    ds_read_b64_tr_b16 a[56:57], v2 offset:43008
    ds_read_b64_tr_b16 a[58:59], v2 offset:43520
    v_accvgpr_read_b32 v24, a76
    s_lshl_b32 s59, s55, 7
    v_mul_u32_u24 v24, 3456, v24
    buffer_load_dword a77, v24, s[60:63], s59 offen
    v_mfma_f32_32x32x16_bf16 v[160:175], a[68:71], v[104:107], v[160:175]
    ds_read_b64_tr_b16 a[60:61], v1 offset:45056
    ds_read_b64_tr_b16 a[62:63], v1 offset:45568
    s_cmp_lt_u32 s58, s40
    s_cselect_b32 s51, 1, 0
    s_add_u32 s55, s42, s58
    s_mov_b32 s60, s8
    v_mfma_f32_32x32x16_bf16 v[176:191], a[72:75], v[104:107], v[176:191]
    ds_read_b64_tr_b16 a[64:65], v2 offset:45056
    ds_read_b64_tr_b16 a[66:67], v2 offset:45568
    s_mov_b32 s61, s9
    s_mul_i32 s62, s51, 5308416
    v_accvgpr_read_b32 v24, a76
    s_waitcnt lgkmcnt(4)
    v_mfma_f32_32x32x16_bf16 v[160:175], a[44:47], v[108:111], v[160:175]
    ds_read_b64_tr_b16 a[68:69], v1 offset:47104
    ds_read_b64_tr_b16 a[70:71], v1 offset:47616
    s_lshl_b32 s59, s55, 7
    v_mul_u32_u24 v24, 9216, v24
    buffer_load_dword a77, v24, s[60:63], s59 offen
    s_mov_b32 s60, s10
    v_mfma_f32_32x32x16_bf16 v[176:191], a[48:51], v[108:111], v[176:191]
    ds_read_b64_tr_b16 a[72:73], v2 offset:47104
    ds_read_b64_tr_b16 a[74:75], v2 offset:47616
    s_mov_b32 s61, s11
    s_mul_i32 s62, s51, 5308416
    v_accvgpr_read_b32 v24, a76
    s_lshl_b32 s59, s55, 7
    v_mfma_f32_32x32x16_bf16 v[160:175], a[52:55], v[112:115], v[160:175]
    ds_read_b64_tr_b16 a[44:45], v1 offset:49152
    ds_read_b64_tr_b16 a[46:47], v1 offset:49664
    v_mul_u32_u24 v24, 9216, v24
    buffer_load_dword a77, v24, s[60:63], s59 offen
    s_add_u32 s58, s43, 1
    s_cmp_lt_u32 s58, s39
    v_mfma_f32_32x32x16_bf16 v[176:191], a[56:59], v[112:115], v[176:191]
    ds_read_b64_tr_b16 a[48:49], v2 offset:49152
    ds_read_b64_tr_b16 a[50:51], v2 offset:49664
    s_cselect_b32 s16, s6, s8
    s_cselect_b32 s17, s7, s9
    s_cselect_b32 s51, s41, s42
    s_waitcnt lgkmcnt(4)
    v_mfma_f32_32x32x16_bf16 v[160:175], a[60:63], v[116:119], v[160:175]
    ds_read_b64_tr_b16 a[52:53], v1 offset:51200
    ds_read_b64_tr_b16 a[54:55], v1 offset:51712
    s_mov_b32 s59, 9216
    s_cselect_b32 s30, 3456, s59
    s_add_u32 s51, s51, s58
    s_mul_i32 s18, s30, 576
    v_mfma_f32_32x32x16_bf16 v[176:191], a[64:67], v[116:119], v[176:191]
    ds_read_b64_tr_b16 a[56:57], v2 offset:51200
    ds_read_b64_tr_b16 a[58:59], v2 offset:51712
    s_cmp_lt_u32 s58, s40
    s_cselect_b32 s18, s18, 0
    s_mul_i32 s28, s36, s30
    s_mul_i32 s28, s28, 24
    v_mfma_f32_32x32x16_bf16 v[160:175], a[68:71], v[120:123], v[160:175]
    ds_read_b64_tr_b16 a[60:61], v1 offset:53248
    ds_read_b64_tr_b16 a[62:63], v1 offset:53760
    s_lshl_b32 s50, s51, 7
    s_add_u32 s28, s28, s50
    s_mul_i32 s29, s30, 96
    v_mad_u32_u24 v5, v3, s30, v4
    v_mfma_f32_32x32x16_bf16 v[176:191], a[72:75], v[120:123], v[176:191]
    ds_read_b64_tr_b16 a[64:65], v2 offset:53248
    ds_read_b64_tr_b16 a[66:67], v2 offset:53760
    s_lshl_b32 s50, s30, 3
    s_sub_u32 s50, s50, 1024
    v_add_u32 v6, s50, v5
    s_waitcnt lgkmcnt(4)
    v_mfma_f32_32x32x16_bf16 v[160:175], a[44:47], v[124:127], v[160:175]
    ds_read_b64_tr_b16 a[68:69], v1 offset:55296
    ds_read_b64_tr_b16 a[70:71], v1 offset:55808
    v_add_u32 v7, s50, v6
    buffer_store_dwordx4 v[224:227], v8, s[32:35], s47 offen offset:0 sc1
    v_mul_f32 v200, v232, v200
    v_mfma_f32_32x32x16_bf16 v[176:191], a[48:51], v[124:127], v[176:191]
    ds_read_b64_tr_b16 a[72:73], v2 offset:55296
    ds_read_b64_tr_b16 a[74:75], v2 offset:55808
    v_mul_f32 v201, v233, v201
    v_mul_f32 v202, v234, v202
    v_mfma_f32_32x32x16_bf16 v[160:175], a[52:55], v[128:131], v[160:175]
    ds_read_b64_tr_b16 a[44:45], v1 offset:57344
    ds_read_b64_tr_b16 a[46:47], v1 offset:57856
    v_mul_f32 v203, v235, v203
    v_mul_f32 v204, v236, v204
    v_mul_f32 v205, v237, v205
    v_mfma_f32_32x32x16_bf16 v[176:191], a[56:59], v[128:131], v[176:191]
    ds_read_b64_tr_b16 a[48:49], v2 offset:57344
    ds_read_b64_tr_b16 a[50:51], v2 offset:57856
    v_mul_f32 v206, v238, v206
    v_mul_f32 v207, v239, v207
    s_waitcnt lgkmcnt(4)
    v_mfma_f32_32x32x16_bf16 v[160:175], a[60:63], v[132:135], v[160:175]
    ds_read_b64_tr_b16 a[52:53], v1 offset:59392
    ds_read_b64_tr_b16 a[54:55], v1 offset:59904
    v_cvt_pk_bf16_f32 v228, v200, v201
    v_cvt_pk_bf16_f32 v229, v202, v203
    v_cvt_pk_bf16_f32 v230, v204, v205
    v_mfma_f32_32x32x16_bf16 v[176:191], a[64:67], v[132:135], v[176:191]
    ds_read_b64_tr_b16 a[56:57], v2 offset:59392
    ds_read_b64_tr_b16 a[58:59], v2 offset:59904
    v_cvt_pk_bf16_f32 v231, v206, v207
    buffer_store_dwordx4 v[228:231], v8, s[32:35], s47 offen offset:1024 sc1
    v_mul_f32 v208, v240, v208
    v_mfma_f32_32x32x16_bf16 v[160:175], a[68:71], v[136:139], v[160:175]
    ds_read_b64_tr_b16 a[60:61], v1 offset:61440
    ds_read_b64_tr_b16 a[62:63], v1 offset:61952
    v_mul_f32 v209, v241, v209
    v_mul_f32 v210, v242, v210
    v_mul_f32 v211, v243, v211
    v_mfma_f32_32x32x16_bf16 v[176:191], a[72:75], v[136:139], v[176:191]
    ds_read_b64_tr_b16 a[64:65], v2 offset:61440
    ds_read_b64_tr_b16 a[66:67], v2 offset:61952
    v_mul_f32 v212, v244, v212
    v_mul_f32 v213, v245, v213
    s_waitcnt lgkmcnt(4)
    v_mfma_f32_32x32x16_bf16 v[160:175], a[44:47], v[140:143], v[160:175]
    ds_read_b64_tr_b16 a[68:69], v1 offset:63488
    ds_read_b64_tr_b16 a[70:71], v1 offset:64000
    v_mul_f32 v214, v246, v214
    v_mul_f32 v215, v247, v215
    v_cvt_pk_bf16_f32 v240, v208, v209
    v_mfma_f32_32x32x16_bf16 v[176:191], a[48:51], v[140:143], v[176:191]
    ds_read_b64_tr_b16 a[72:73], v2 offset:63488
    ds_read_b64_tr_b16 a[74:75], v2 offset:64000
    v_cvt_pk_bf16_f32 v241, v210, v211
    v_cvt_pk_bf16_f32 v242, v212, v213
    v_mfma_f32_32x32x16_bf16 v[160:175], a[52:55], v[144:147], v[160:175]
    v_add_u32 v1, 0x10000, v1
    v_add_u32 v2, 0x10000, v2
    ds_read_b64_tr_b16 a[44:45], v1 offset:0
    ds_read_b64_tr_b16 a[46:47], v1 offset:512
    v_cvt_pk_bf16_f32 v243, v214, v215
    buffer_store_dwordx4 v[240:243], v8, s[32:35], s47 offen offset:2048 sc1
    v_mfma_f32_32x32x16_bf16 v[176:191], a[56:59], v[144:147], v[176:191]
    ds_read_b64_tr_b16 a[48:49], v2 offset:0
    ds_read_b64_tr_b16 a[50:51], v2 offset:512
    v_mul_f32 v216, v248, v216
    v_mul_f32 v217, v249, v217
    s_waitcnt lgkmcnt(4)
    v_mfma_f32_32x32x16_bf16 v[160:175], a[60:63], v[148:151], v[160:175]
    ds_read_b64_tr_b16 a[52:53], v1 offset:2048
    ds_read_b64_tr_b16 a[54:55], v1 offset:2560
    v_mul_f32 v218, v250, v218
    v_mul_f32 v219, v251, v219
    v_mul_f32 v220, v252, v220
    v_mfma_f32_32x32x16_bf16 v[176:191], a[64:67], v[148:151], v[176:191]
    ds_read_b64_tr_b16 a[56:57], v2 offset:2048
    ds_read_b64_tr_b16 a[58:59], v2 offset:2560
    v_mul_f32 v221, v253, v221
    v_mul_f32 v222, v254, v222
    v_mul_f32 v223, v255, v223
    v_mfma_f32_32x32x16_bf16 v[160:175], a[68:71], v[152:155], v[160:175]
    ds_read_b64_tr_b16 a[60:61], v1 offset:4096
    ds_read_b64_tr_b16 a[62:63], v1 offset:4608
    v_cvt_pk_bf16_f32 v244, v216, v217
    v_cvt_pk_bf16_f32 v245, v218, v219
    v_mfma_f32_32x32x16_bf16 v[176:191], a[72:75], v[152:155], v[176:191]
    ds_read_b64_tr_b16 a[64:65], v2 offset:4096
    ds_read_b64_tr_b16 a[66:67], v2 offset:4608
    v_cvt_pk_bf16_f32 v246, v220, v221
    v_cvt_pk_bf16_f32 v247, v222, v223
    buffer_store_dwordx4 v[244:247], v8, s[32:35], s47 offen offset:3072 sc1
    s_waitcnt lgkmcnt(4)
    v_mfma_f32_32x32x16_bf16 v[160:175], a[44:47], v[156:159], v[160:175]
    ds_read_b64_tr_b16 a[68:69], v1 offset:6144
    ds_read_b64_tr_b16 a[70:71], v1 offset:6656
    v_mfma_f32_32x32x16_bf16 v[176:191], a[48:51], v[156:159], v[176:191]
    ds_read_b64_tr_b16 a[72:73], v2 offset:6144
    ds_read_b64_tr_b16 a[74:75], v2 offset:6656
    v_mfma_f32_32x32x16_bf16 v[160:175], a[52:55], a[0:3], v[160:175]
    v_mfma_f32_32x32x16_bf16 v[176:191], a[56:59], a[0:3], v[176:191]
    s_waitcnt lgkmcnt(0)
    v_mfma_f32_32x32x16_bf16 v[160:175], a[60:63], a[4:7], v[160:175]
    s_waitcnt vmcnt(7)
    s_barrier
    v_add_u32 v1, s46, v1
    v_add_u32 v2, s46, v2
    ds_read_b64_tr_b16 a[44:45], v1 offset:0
    ds_read_b64_tr_b16 a[46:47], v1 offset:512
    ds_read_b64_tr_b16 a[52:53], v1 offset:2048
    ds_read_b64_tr_b16 a[54:55], v1 offset:2560
    v_mfma_f32_32x32x16_bf16 v[176:191], a[64:67], a[4:7], v[176:191]
    ds_read_b64_tr_b16 a[48:49], v2 offset:0
    ds_read_b64_tr_b16 a[50:51], v2 offset:512
    ds_read_b64_tr_b16 a[56:57], v2 offset:2048
    ds_read_b64_tr_b16 a[58:59], v2 offset:2560
    v_mfma_f32_32x32x16_bf16 v[160:175], a[68:71], a[8:11], v[160:175]
    ds_read_b64_tr_b16 a[60:61], v1 offset:4096
    ds_read_b64_tr_b16 a[62:63], v1 offset:4608
    v_mfma_f32_32x32x16_bf16 v[176:191], a[72:75], a[8:11], v[176:191]
    ds_read_b64_tr_b16 a[64:65], v2 offset:4096
    ds_read_b64_tr_b16 a[66:67], v2 offset:4608
K1_UP:
    s_waitcnt lgkmcnt(4)
    v_mfma_f32_32x32x16_bf16 v[192:207], a[44:47], v[28:31], 0
    ds_read_b64_tr_b16 a[68:69], v1 offset:6144
    ds_read_b64_tr_b16 a[70:71], v1 offset:6656
    s_add_u32 s43, s43, 1
    s_mul_i32 s50, s36, 3072
    s_add_u32 m0, s53, s50
    s_lshl_b32 s50, s53, 1
    v_mfma_f32_32x32x16_bf16 v[208:223], a[48:51], v[28:31], 0
    ds_read_b64_tr_b16 a[72:73], v2 offset:6144
    ds_read_b64_tr_b16 a[74:75], v2 offset:6656
    s_sub_u32 s46, s50, 139264
    s_sub_u32 s53, 73728, s53
    v_mfma_f32_32x32x16_bf16 v[192:207], a[52:55], v[32:35], v[192:207]
    ds_read_b64_tr_b16 a[44:45], v1 offset:8192
    ds_read_b64_tr_b16 a[46:47], v1 offset:8704
    v_exp_f32_e64 v12, -v160
    v_mfma_f32_32x32x16_bf16 v[208:223], a[56:59], v[32:35], v[208:223]
    ds_read_b64_tr_b16 a[48:49], v2 offset:8192
    ds_read_b64_tr_b16 a[50:51], v2 offset:8704
    v_exp_f32_e64 v13, -v161
    v_fma_f32 v12, v12, v10, v10
    s_waitcnt lgkmcnt(4)
    v_mfma_f32_32x32x16_bf16 v[192:207], a[60:63], v[36:39], v[192:207]
    ds_read_b64_tr_b16 a[52:53], v1 offset:10240
    ds_read_b64_tr_b16 a[54:55], v1 offset:10752
    v_exp_f32_e64 v14, -v162
    v_fma_f32 v13, v13, v10, v10
    v_rcp_f32 v12, v12
    v_mfma_f32_32x32x16_bf16 v[208:223], a[64:67], v[36:39], v[208:223]
    ds_read_b64_tr_b16 a[56:57], v2 offset:10240
    ds_read_b64_tr_b16 a[58:59], v2 offset:10752
    buffer_load_dwordx4 v5, s[16:19], s28 offen offset:0 lds
    v_exp_f32_e64 v15, -v163
    v_fma_f32 v14, v14, v10, v10
    v_mfma_f32_32x32x16_bf16 v[192:207], a[68:71], v[40:43], v[192:207]
    ds_read_b64_tr_b16 a[60:61], v1 offset:12288
    ds_read_b64_tr_b16 a[62:63], v1 offset:12800
    buffer_load_dwordx4 v6, s[16:19], s28 offen offset:1024 lds
    v_rcp_f32 v13, v13
    v_mul_f32 v224, v160, v12
    v_mfma_f32_32x32x16_bf16 v[208:223], a[72:75], v[40:43], v[208:223]
    ds_read_b64_tr_b16 a[64:65], v2 offset:12288
    ds_read_b64_tr_b16 a[66:67], v2 offset:12800
    buffer_load_dwordx4 v7, s[16:19], s28 offen offset:2048 lds
    v_exp_f32_e64 v16, -v164
    s_waitcnt lgkmcnt(4)
    v_mfma_f32_32x32x16_bf16 v[192:207], a[44:47], v[44:47], v[192:207]
    ds_read_b64_tr_b16 a[68:69], v1 offset:14336
    ds_read_b64_tr_b16 a[70:71], v1 offset:14848
    s_add_u32 m0, m0, 12288
    v_fma_f32 v15, v15, v10, v10
    v_rcp_f32 v14, v14
    v_mfma_f32_32x32x16_bf16 v[208:223], a[48:51], v[44:47], v[208:223]
    ds_read_b64_tr_b16 a[72:73], v2 offset:14336
    ds_read_b64_tr_b16 a[74:75], v2 offset:14848
    s_add_u32 s28, s28, s29
    v_mul_f32 v225, v161, v13
    v_exp_f32_e64 v12, -v165
    v_mfma_f32_32x32x16_bf16 v[192:207], a[52:55], v[48:51], v[192:207]
    ds_read_b64_tr_b16 a[44:45], v1 offset:16384
    ds_read_b64_tr_b16 a[46:47], v1 offset:16896
    buffer_load_dwordx4 v5, s[16:19], s28 offen offset:0 lds
    v_fma_f32 v16, v16, v10, v10
    v_mfma_f32_32x32x16_bf16 v[208:223], a[56:59], v[48:51], v[208:223]
    ds_read_b64_tr_b16 a[48:49], v2 offset:16384
    ds_read_b64_tr_b16 a[50:51], v2 offset:16896
    buffer_load_dwordx4 v6, s[16:19], s28 offen offset:1024 lds
    v_rcp_f32 v15, v15
    v_mul_f32 v226, v162, v14
    s_waitcnt lgkmcnt(4)
    v_mfma_f32_32x32x16_bf16 v[192:207], a[60:63], v[52:55], v[192:207]
    ds_read_b64_tr_b16 a[52:53], v1 offset:18432
    ds_read_b64_tr_b16 a[54:55], v1 offset:18944
    buffer_load_dwordx4 v7, s[16:19], s28 offen offset:2048 lds
    v_exp_f32_e64 v13, -v166
    v_fma_f32 v12, v12, v10, v10
    v_mfma_f32_32x32x16_bf16 v[208:223], a[64:67], v[52:55], v[208:223]
    ds_read_b64_tr_b16 a[56:57], v2 offset:18432
    ds_read_b64_tr_b16 a[58:59], v2 offset:18944
    s_add_u32 m0, m0, 12288
    v_rcp_f32 v16, v16
    v_mul_f32 v227, v163, v15
    v_mfma_f32_32x32x16_bf16 v[192:207], a[68:71], v[56:59], v[192:207]
    ds_read_b64_tr_b16 a[60:61], v1 offset:20480
    ds_read_b64_tr_b16 a[62:63], v1 offset:20992
    s_add_u32 s28, s28, s29
    v_exp_f32_e64 v14, -v167
    v_fma_f32 v13, v13, v10, v10
    v_mfma_f32_32x32x16_bf16 v[208:223], a[72:75], v[56:59], v[208:223]
    ds_read_b64_tr_b16 a[64:65], v2 offset:20480
    ds_read_b64_tr_b16 a[66:67], v2 offset:20992
    buffer_load_dwordx4 v5, s[16:19], s28 offen offset:0 lds
    v_rcp_f32 v12, v12
    s_waitcnt lgkmcnt(4)
    v_mfma_f32_32x32x16_bf16 v[192:207], a[44:47], v[60:63], v[192:207]
    ds_read_b64_tr_b16 a[68:69], v1 offset:22528
    ds_read_b64_tr_b16 a[70:71], v1 offset:23040
    buffer_load_dwordx4 v6, s[16:19], s28 offen offset:1024 lds
    v_mul_f32 v228, v164, v16
    v_exp_f32_e64 v15, -v168
    v_mfma_f32_32x32x16_bf16 v[208:223], a[48:51], v[60:63], v[208:223]
    ds_read_b64_tr_b16 a[72:73], v2 offset:22528
    ds_read_b64_tr_b16 a[74:75], v2 offset:23040
    buffer_load_dwordx4 v7, s[16:19], s28 offen offset:2048 lds
    v_fma_f32 v14, v14, v10, v10
    v_rcp_f32 v13, v13
    v_mfma_f32_32x32x16_bf16 v[192:207], a[52:55], v[64:67], v[192:207]
    ds_read_b64_tr_b16 a[44:45], v1 offset:24576
    ds_read_b64_tr_b16 a[46:47], v1 offset:25088
    s_add_u32 m0, m0, 12288
    v_mul_f32 v229, v165, v12
    v_exp_f32_e64 v16, -v169
    v_mfma_f32_32x32x16_bf16 v[208:223], a[56:59], v[64:67], v[208:223]
    ds_read_b64_tr_b16 a[48:49], v2 offset:24576
    ds_read_b64_tr_b16 a[50:51], v2 offset:25088
    s_add_u32 s28, s28, s29
    v_fma_f32 v15, v15, v10, v10
    s_waitcnt lgkmcnt(4)
    v_mfma_f32_32x32x16_bf16 v[192:207], a[60:63], v[68:71], v[192:207]
    ds_read_b64_tr_b16 a[52:53], v1 offset:26624
    ds_read_b64_tr_b16 a[54:55], v1 offset:27136
    buffer_load_dwordx4 v5, s[16:19], s28 offen offset:0 lds
    v_rcp_f32 v14, v14
    v_mul_f32 v230, v166, v13
    v_mfma_f32_32x32x16_bf16 v[208:223], a[64:67], v[68:71], v[208:223]
    ds_read_b64_tr_b16 a[56:57], v2 offset:26624
    ds_read_b64_tr_b16 a[58:59], v2 offset:27136
    buffer_load_dwordx4 v6, s[16:19], s28 offen offset:1024 lds
    v_exp_f32_e64 v12, -v170
    v_fma_f32 v16, v16, v10, v10
    v_mfma_f32_32x32x16_bf16 v[192:207], a[68:71], v[72:75], v[192:207]
    ds_read_b64_tr_b16 a[60:61], v1 offset:28672
    ds_read_b64_tr_b16 a[62:63], v1 offset:29184
    buffer_load_dwordx4 v7, s[16:19], s28 offen offset:2048 lds
    v_rcp_f32 v15, v15
    v_mul_f32 v231, v167, v14
    v_mfma_f32_32x32x16_bf16 v[208:223], a[72:75], v[72:75], v[208:223]
    ds_read_b64_tr_b16 a[64:65], v2 offset:28672
    ds_read_b64_tr_b16 a[66:67], v2 offset:29184
    s_add_u32 m0, m0, 12288
    v_exp_f32_e64 v13, -v171
    s_waitcnt lgkmcnt(4)
    v_mfma_f32_32x32x16_bf16 v[192:207], a[44:47], v[76:79], v[192:207]
    ds_read_b64_tr_b16 a[68:69], v1 offset:30720
    ds_read_b64_tr_b16 a[70:71], v1 offset:31232
    s_add_u32 s28, s28, s29
    v_fma_f32 v12, v12, v10, v10
    v_rcp_f32 v16, v16
    v_mfma_f32_32x32x16_bf16 v[208:223], a[48:51], v[76:79], v[208:223]
    ds_read_b64_tr_b16 a[72:73], v2 offset:30720
    ds_read_b64_tr_b16 a[74:75], v2 offset:31232
    buffer_load_dwordx4 v5, s[16:19], s28 offen offset:0 lds
    v_mul_f32 v232, v168, v15
    v_exp_f32_e64 v14, -v172
    v_mfma_f32_32x32x16_bf16 v[192:207], a[52:55], v[80:83], v[192:207]
    ds_read_b64_tr_b16 a[44:45], v1 offset:32768
    ds_read_b64_tr_b16 a[46:47], v1 offset:33280
    buffer_load_dwordx4 v6, s[16:19], s28 offen offset:1024 lds
    v_fma_f32 v13, v13, v10, v10
    v_rcp_f32 v12, v12
    v_mfma_f32_32x32x16_bf16 v[208:223], a[56:59], v[80:83], v[208:223]
    ds_read_b64_tr_b16 a[48:49], v2 offset:32768
    ds_read_b64_tr_b16 a[50:51], v2 offset:33280
    buffer_load_dwordx4 v7, s[16:19], s28 offen offset:2048 lds
    v_mul_f32 v233, v169, v16
    s_waitcnt lgkmcnt(4)
    v_mfma_f32_32x32x16_bf16 v[192:207], a[60:63], v[84:87], v[192:207]
    ds_read_b64_tr_b16 a[52:53], v1 offset:34816
    ds_read_b64_tr_b16 a[54:55], v1 offset:35328
    s_add_u32 m0, m0, 12288
    v_exp_f32_e64 v15, -v173
    v_fma_f32 v14, v14, v10, v10
    v_mfma_f32_32x32x16_bf16 v[208:223], a[64:67], v[84:87], v[208:223]
    ds_read_b64_tr_b16 a[56:57], v2 offset:34816
    ds_read_b64_tr_b16 a[58:59], v2 offset:35328
    s_add_u32 s28, s28, s29
    v_rcp_f32 v13, v13
    v_mul_f32 v234, v170, v12
    v_mfma_f32_32x32x16_bf16 v[192:207], a[68:71], v[88:91], v[192:207]
    ds_read_b64_tr_b16 a[60:61], v1 offset:36864
    ds_read_b64_tr_b16 a[62:63], v1 offset:37376
    buffer_load_dwordx4 v5, s[16:19], s28 offen offset:0 lds
    v_exp_f32_e64 v16, -v174
    v_fma_f32 v15, v15, v10, v10
    v_mfma_f32_32x32x16_bf16 v[208:223], a[72:75], v[88:91], v[208:223]
    ds_read_b64_tr_b16 a[64:65], v2 offset:36864
    ds_read_b64_tr_b16 a[66:67], v2 offset:37376
    buffer_load_dwordx4 v6, s[16:19], s28 offen offset:1024 lds
    v_rcp_f32 v14, v14
    s_waitcnt lgkmcnt(4)
    v_mfma_f32_32x32x16_bf16 v[192:207], a[44:47], v[92:95], v[192:207]
    ds_read_b64_tr_b16 a[68:69], v1 offset:38912
    ds_read_b64_tr_b16 a[70:71], v1 offset:39424
    buffer_load_dwordx4 v7, s[16:19], s28 offen offset:2048 lds
    v_mul_f32 v235, v171, v13
    v_exp_f32_e64 v12, -v175
    v_mfma_f32_32x32x16_bf16 v[208:223], a[48:51], v[92:95], v[208:223]
    ds_read_b64_tr_b16 a[72:73], v2 offset:38912
    ds_read_b64_tr_b16 a[74:75], v2 offset:39424
    s_add_u32 m0, m0, 12288
    v_fma_f32 v16, v16, v10, v10
    v_rcp_f32 v15, v15
    v_mfma_f32_32x32x16_bf16 v[192:207], a[52:55], v[96:99], v[192:207]
    ds_read_b64_tr_b16 a[44:45], v1 offset:40960
    ds_read_b64_tr_b16 a[46:47], v1 offset:41472
    s_add_u32 s28, s28, s29
    v_mul_f32 v236, v172, v14
    v_exp_f32_e64 v13, -v176
    v_mfma_f32_32x32x16_bf16 v[208:223], a[56:59], v[96:99], v[208:223]
    ds_read_b64_tr_b16 a[48:49], v2 offset:40960
    ds_read_b64_tr_b16 a[50:51], v2 offset:41472
    v_fma_f32 v12, v12, v10, v10
    v_rcp_f32 v16, v16
    s_waitcnt lgkmcnt(4)
    v_mfma_f32_32x32x16_bf16 v[192:207], a[60:63], v[100:103], v[192:207]
    ds_read_b64_tr_b16 a[52:53], v1 offset:43008
    ds_read_b64_tr_b16 a[54:55], v1 offset:43520
    v_mul_f32 v237, v173, v15
    v_exp_f32_e64 v14, -v177
    v_mfma_f32_32x32x16_bf16 v[208:223], a[64:67], v[100:103], v[208:223]
    ds_read_b64_tr_b16 a[56:57], v2 offset:43008
    ds_read_b64_tr_b16 a[58:59], v2 offset:43520
    v_fma_f32 v13, v13, v10, v10
    v_rcp_f32 v12, v12
    v_mul_f32 v238, v174, v16
    v_mfma_f32_32x32x16_bf16 v[192:207], a[68:71], v[104:107], v[192:207]
    ds_read_b64_tr_b16 a[60:61], v1 offset:45056
    ds_read_b64_tr_b16 a[62:63], v1 offset:45568
    v_exp_f32_e64 v15, -v178
    v_fma_f32 v14, v14, v10, v10
    v_mfma_f32_32x32x16_bf16 v[208:223], a[72:75], v[104:107], v[208:223]
    ds_read_b64_tr_b16 a[64:65], v2 offset:45056
    ds_read_b64_tr_b16 a[66:67], v2 offset:45568
    v_rcp_f32 v13, v13
    v_mul_f32 v239, v175, v12
    s_waitcnt lgkmcnt(4)
    v_mfma_f32_32x32x16_bf16 v[192:207], a[44:47], v[108:111], v[192:207]
    ds_read_b64_tr_b16 a[68:69], v1 offset:47104
    ds_read_b64_tr_b16 a[70:71], v1 offset:47616
    v_exp_f32_e64 v16, -v179
    v_fma_f32 v15, v15, v10, v10
    v_rcp_f32 v14, v14
    v_mfma_f32_32x32x16_bf16 v[208:223], a[48:51], v[108:111], v[208:223]
    ds_read_b64_tr_b16 a[72:73], v2 offset:47104
    ds_read_b64_tr_b16 a[74:75], v2 offset:47616
    v_mul_f32 v240, v176, v13
    v_exp_f32_e64 v12, -v180
    v_fma_f32 v16, v16, v10, v10
    v_mfma_f32_32x32x16_bf16 v[192:207], a[52:55], v[112:115], v[192:207]
    ds_read_b64_tr_b16 a[44:45], v1 offset:49152
    ds_read_b64_tr_b16 a[46:47], v1 offset:49664
    v_rcp_f32 v15, v15
    v_mul_f32 v241, v177, v14
    v_mfma_f32_32x32x16_bf16 v[208:223], a[56:59], v[112:115], v[208:223]
    ds_read_b64_tr_b16 a[48:49], v2 offset:49152
    ds_read_b64_tr_b16 a[50:51], v2 offset:49664
    v_exp_f32_e64 v13, -v181
    v_fma_f32 v12, v12, v10, v10
    s_waitcnt lgkmcnt(4)
    v_mfma_f32_32x32x16_bf16 v[192:207], a[60:63], v[116:119], v[192:207]
    ds_read_b64_tr_b16 a[52:53], v1 offset:51200
    ds_read_b64_tr_b16 a[54:55], v1 offset:51712
    v_rcp_f32 v16, v16
    v_mul_f32 v242, v178, v15
    v_mfma_f32_32x32x16_bf16 v[208:223], a[64:67], v[116:119], v[208:223]
    ds_read_b64_tr_b16 a[56:57], v2 offset:51200
    ds_read_b64_tr_b16 a[58:59], v2 offset:51712
    v_exp_f32_e64 v14, -v182
    v_fma_f32 v13, v13, v10, v10
    v_rcp_f32 v12, v12
    v_mfma_f32_32x32x16_bf16 v[192:207], a[68:71], v[120:123], v[192:207]
    ds_read_b64_tr_b16 a[60:61], v1 offset:53248
    ds_read_b64_tr_b16 a[62:63], v1 offset:53760
    v_mul_f32 v243, v179, v16
    v_exp_f32_e64 v15, -v183
    v_fma_f32 v14, v14, v10, v10
    v_mfma_f32_32x32x16_bf16 v[208:223], a[72:75], v[120:123], v[208:223]
    ds_read_b64_tr_b16 a[64:65], v2 offset:53248
    ds_read_b64_tr_b16 a[66:67], v2 offset:53760
    v_rcp_f32 v13, v13
    v_mul_f32 v244, v180, v12
    s_waitcnt lgkmcnt(4)
    v_mfma_f32_32x32x16_bf16 v[192:207], a[44:47], v[124:127], v[192:207]
    ds_read_b64_tr_b16 a[68:69], v1 offset:55296
    ds_read_b64_tr_b16 a[70:71], v1 offset:55808
    v_exp_f32_e64 v16, -v184
    v_fma_f32 v15, v15, v10, v10
    v_mfma_f32_32x32x16_bf16 v[208:223], a[48:51], v[124:127], v[208:223]
    ds_read_b64_tr_b16 a[72:73], v2 offset:55296
    ds_read_b64_tr_b16 a[74:75], v2 offset:55808
    v_rcp_f32 v14, v14
    v_mul_f32 v245, v181, v13
    v_exp_f32_e64 v12, -v185
    v_mfma_f32_32x32x16_bf16 v[192:207], a[52:55], v[128:131], v[192:207]
    ds_read_b64_tr_b16 a[44:45], v1 offset:57344
    ds_read_b64_tr_b16 a[46:47], v1 offset:57856
    v_fma_f32 v16, v16, v10, v10
    v_rcp_f32 v15, v15
    v_mfma_f32_32x32x16_bf16 v[208:223], a[56:59], v[128:131], v[208:223]
    ds_read_b64_tr_b16 a[48:49], v2 offset:57344
    ds_read_b64_tr_b16 a[50:51], v2 offset:57856
    v_mul_f32 v246, v182, v14
    v_exp_f32_e64 v13, -v186
    s_waitcnt lgkmcnt(4)
    v_mfma_f32_32x32x16_bf16 v[192:207], a[60:63], v[132:135], v[192:207]
    ds_read_b64_tr_b16 a[52:53], v1 offset:59392
    ds_read_b64_tr_b16 a[54:55], v1 offset:59904
    v_fma_f32 v12, v12, v10, v10
    v_rcp_f32 v16, v16
    v_mul_f32 v247, v183, v15
    v_mfma_f32_32x32x16_bf16 v[208:223], a[64:67], v[132:135], v[208:223]
    ds_read_b64_tr_b16 a[56:57], v2 offset:59392
    ds_read_b64_tr_b16 a[58:59], v2 offset:59904
    v_exp_f32_e64 v14, -v187
    v_fma_f32 v13, v13, v10, v10
    v_mfma_f32_32x32x16_bf16 v[192:207], a[68:71], v[136:139], v[192:207]
    ds_read_b64_tr_b16 a[60:61], v1 offset:61440
    ds_read_b64_tr_b16 a[62:63], v1 offset:61952
    v_rcp_f32 v12, v12
    v_mul_f32 v248, v184, v16
    v_exp_f32_e64 v15, -v188
    v_mfma_f32_32x32x16_bf16 v[208:223], a[72:75], v[136:139], v[208:223]
    ds_read_b64_tr_b16 a[64:65], v2 offset:61440
    ds_read_b64_tr_b16 a[66:67], v2 offset:61952
    v_fma_f32 v14, v14, v10, v10
    v_rcp_f32 v13, v13
    s_waitcnt lgkmcnt(4)
    v_mfma_f32_32x32x16_bf16 v[192:207], a[44:47], v[140:143], v[192:207]
    ds_read_b64_tr_b16 a[68:69], v1 offset:63488
    ds_read_b64_tr_b16 a[70:71], v1 offset:64000
    v_mul_f32 v249, v185, v12
    v_exp_f32_e64 v16, -v189
    v_mfma_f32_32x32x16_bf16 v[208:223], a[48:51], v[140:143], v[208:223]
    ds_read_b64_tr_b16 a[72:73], v2 offset:63488
    ds_read_b64_tr_b16 a[74:75], v2 offset:64000
    v_fma_f32 v15, v15, v10, v10
    v_rcp_f32 v14, v14
    v_mul_f32 v250, v186, v13
    v_mfma_f32_32x32x16_bf16 v[192:207], a[52:55], v[144:147], v[192:207]
    v_add_u32 v1, 0x10000, v1
    v_add_u32 v2, 0x10000, v2
    ds_read_b64_tr_b16 a[44:45], v1 offset:0
    ds_read_b64_tr_b16 a[46:47], v1 offset:512
    v_exp_f32_e64 v12, -v190
    v_mfma_f32_32x32x16_bf16 v[208:223], a[56:59], v[144:147], v[208:223]
    ds_read_b64_tr_b16 a[48:49], v2 offset:0
    ds_read_b64_tr_b16 a[50:51], v2 offset:512
    v_fma_f32 v16, v16, v10, v10
    v_rcp_f32 v15, v15
    s_waitcnt lgkmcnt(4)
    v_mfma_f32_32x32x16_bf16 v[192:207], a[60:63], v[148:151], v[192:207]
    ds_read_b64_tr_b16 a[52:53], v1 offset:2048
    ds_read_b64_tr_b16 a[54:55], v1 offset:2560
    v_mul_f32 v251, v187, v14
    v_exp_f32_e64 v13, -v191
    v_fma_f32 v12, v12, v10, v10
    v_mfma_f32_32x32x16_bf16 v[208:223], a[64:67], v[148:151], v[208:223]
    ds_read_b64_tr_b16 a[56:57], v2 offset:2048
    ds_read_b64_tr_b16 a[58:59], v2 offset:2560
    v_rcp_f32 v16, v16
    v_mul_f32 v252, v188, v15
    v_fma_f32 v13, v13, v10, v10
    v_mfma_f32_32x32x16_bf16 v[192:207], a[68:71], v[152:155], v[192:207]
    ds_read_b64_tr_b16 a[60:61], v1 offset:4096
    ds_read_b64_tr_b16 a[62:63], v1 offset:4608
    v_rcp_f32 v12, v12
    v_mul_f32 v253, v189, v16
    v_mfma_f32_32x32x16_bf16 v[208:223], a[72:75], v[152:155], v[208:223]
    ds_read_b64_tr_b16 a[64:65], v2 offset:4096
    ds_read_b64_tr_b16 a[66:67], v2 offset:4608
    v_rcp_f32 v13, v13
    v_mul_f32 v254, v190, v12
    v_mul_f32 v255, v191, v13
    s_waitcnt lgkmcnt(4)
    v_mfma_f32_32x32x16_bf16 v[192:207], a[44:47], v[156:159], v[192:207]
    ds_read_b64_tr_b16 a[68:69], v1 offset:6144
    ds_read_b64_tr_b16 a[70:71], v1 offset:6656
    v_mfma_f32_32x32x16_bf16 v[208:223], a[48:51], v[156:159], v[208:223]
    ds_read_b64_tr_b16 a[72:73], v2 offset:6144
    ds_read_b64_tr_b16 a[74:75], v2 offset:6656
    v_mfma_f32_32x32x16_bf16 v[192:207], a[52:55], a[0:3], v[192:207]
    v_mfma_f32_32x32x16_bf16 v[208:223], a[56:59], a[0:3], v[208:223]
    s_waitcnt lgkmcnt(0)
    v_mfma_f32_32x32x16_bf16 v[192:207], a[60:63], a[4:7], v[192:207]
    s_waitcnt vmcnt(0)
    s_barrier
    v_add_u32 v1, s46, v1
    v_add_u32 v2, s46, v2
    ds_read_b64_tr_b16 a[44:45], v1 offset:0
    ds_read_b64_tr_b16 a[46:47], v1 offset:512
    ds_read_b64_tr_b16 a[52:53], v1 offset:2048
    ds_read_b64_tr_b16 a[54:55], v1 offset:2560
    v_mfma_f32_32x32x16_bf16 v[208:223], a[64:67], a[4:7], v[208:223]
    ds_read_b64_tr_b16 a[48:49], v2 offset:0
    ds_read_b64_tr_b16 a[50:51], v2 offset:512
    ds_read_b64_tr_b16 a[56:57], v2 offset:2048
    ds_read_b64_tr_b16 a[58:59], v2 offset:2560
    v_mfma_f32_32x32x16_bf16 v[192:207], a[68:71], a[8:11], v[192:207]
    ds_read_b64_tr_b16 a[60:61], v1 offset:4096
    ds_read_b64_tr_b16 a[62:63], v1 offset:4608
    v_mfma_f32_32x32x16_bf16 v[208:223], a[72:75], a[8:11], v[208:223]
    ds_read_b64_tr_b16 a[64:65], v2 offset:4096
    ds_read_b64_tr_b16 a[66:67], v2 offset:4608
    s_add_u32 s51, s42, s43
    s_sub_u32 s51, s51, 1
    s_lshl_b32 s47, s51, 12
    s_mov_b32 s34, 18874368
    s_cmp_lt_u32 s43, s40
    s_cbranch_scc1 K1_LOOP
    s_lshr_b32 s51, s2, 3
    s_lshl_b32 s51, s51, 2
    s_add_u32 s51, s51, s36
    s_getpc_b64 s[60:61]
K1N_PC:
    s_add_u32 s60, s60, k2_attn_kernel-K1N_PC
    s_addc_u32 s61, s61, 0-(((k2_attn_kernel-K1N_PC)>>63)&1)
    s_mov_b32 s62, K2_CODE_END-k2_attn_kernel
    s_mov_b32 s63, 0x00020000
    s_mul_i32 s50, s51, 256
    v_min_u32 v23, 1, v0
    v_lshlrev_b32 v23, 7, v23
    buffer_load_dword a77, v23, s[60:63], s50 offen
    s_nop 7
    s_nop 7
    v_mul_f32 v192, v224, v192
    v_mul_f32 v193, v225, v193
    v_mul_f32 v194, v226, v194
    v_mul_f32 v195, v227, v195
    v_mul_f32 v196, v228, v196
    v_mul_f32 v197, v229, v197
    v_mul_f32 v198, v230, v198
    v_mul_f32 v199, v231, v199
    v_cvt_pk_bf16_f32 v224, v192, v193
    v_cvt_pk_bf16_f32 v225, v194, v195
    v_cvt_pk_bf16_f32 v226, v196, v197
    v_cvt_pk_bf16_f32 v227, v198, v199
    buffer_store_dwordx4 v[224:227], v8, s[32:35], s47 offen offset:0 sc1
    v_mul_f32 v200, v232, v200
    v_mul_f32 v201, v233, v201
    v_mul_f32 v202, v234, v202
    v_mul_f32 v203, v235, v203
    v_mul_f32 v204, v236, v204
    v_mul_f32 v205, v237, v205
    v_mul_f32 v206, v238, v206
    v_mul_f32 v207, v239, v207
    v_cvt_pk_bf16_f32 v228, v200, v201
    v_cvt_pk_bf16_f32 v229, v202, v203
    v_cvt_pk_bf16_f32 v230, v204, v205
    v_cvt_pk_bf16_f32 v231, v206, v207
    buffer_store_dwordx4 v[228:231], v8, s[32:35], s47 offen offset:1024 sc1
    v_mul_f32 v208, v240, v208
    v_mul_f32 v209, v241, v209
    v_mul_f32 v210, v242, v210
    v_mul_f32 v211, v243, v211
    v_mul_f32 v212, v244, v212
    v_mul_f32 v213, v245, v213
    v_mul_f32 v214, v246, v214
    v_mul_f32 v215, v247, v215
    v_cvt_pk_bf16_f32 v240, v208, v209
    v_cvt_pk_bf16_f32 v241, v210, v211
    v_cvt_pk_bf16_f32 v242, v212, v213
    v_cvt_pk_bf16_f32 v243, v214, v215
    buffer_store_dwordx4 v[240:243], v8, s[32:35], s47 offen offset:2048 sc1
    v_mul_f32 v216, v248, v216
    v_mul_f32 v217, v249, v217
    v_mul_f32 v218, v250, v218
    v_mul_f32 v219, v251, v219
    v_mul_f32 v220, v252, v220
    v_mul_f32 v221, v253, v221
    v_mul_f32 v222, v254, v222
    v_mul_f32 v223, v255, v223
    v_cvt_pk_bf16_f32 v244, v216, v217
    v_cvt_pk_bf16_f32 v245, v218, v219
    v_cvt_pk_bf16_f32 v246, v220, v221
    v_cvt_pk_bf16_f32 v247, v222, v223
    buffer_store_dwordx4 v[244:247], v8, s[32:35], s47 offen offset:3072 sc1
K1_END:
    s_endpgm
K1_CODE_END:

.globl k2_attn_kernel
.p2align 8
.type k2_attn_kernel,@function
k2_attn_kernel:

    s_cmp_ge_u32 s2, 256
    s_cbranch_scc1 K2_END
    s_load_dwordx2 s[4:5], s[0:1], 48
    s_load_dwordx2 s[6:7], s[0:1], 72
    s_load_dwordx2 s[52:53], s[0:1], 0
    s_load_dwordx2 s[54:55], s[0:1], 16
    v_lshrrev_b32 v1, 6, v0
    v_and_b32 v0, 63, v0
    v_readfirstlane_b32 s8, v1
    s_nop 3
    s_lshr_b32 s12, s2, 3
    s_lshl_b32 s12, s12, 3
    s_add_u32 s12, s12, s8
    s_getpc_b64 s[20:21]
K2_PC:
    s_add_u32 s20, s20, k2_attn_kernel-K2_PC
    s_addc_u32 s21, s21, 0-(((k2_attn_kernel-K2_PC)>>63)&1)
    s_mov_b32 s22, K2_CODE_END-k2_attn_kernel
    s_mov_b32 s23, 0x00020000
    s_mul_i32 s11, s12, 128
    v_min_u32 v1, 0, v0
    v_lshlrev_b32 v1, 7, v1
    buffer_load_dword v175, v1, s[20:23], s11 offen
    s_and_b32 s9, s2, 7
    s_lshl_b32 s9, s9, 2
    s_lshr_b32 s11, s2, 3
    s_and_b32 s11, s11, 3
    s_add_u32 s9, s9, s11
    s_lshr_b32 s10, s2, 5
    s_waitcnt lgkmcnt(0)
    s_cmp_ge_u32 s8, 4
    s_cbranch_scc1 K2_PROD
    v_and_b32 v146, 31, v0
    v_lshrrev_b32 v147, 5, v0
    s_lshl_b32 s11, s10, 8
    s_lshl_b32 s12, s8, 6
    s_add_u32 s11, s11, s12
    v_add_u32 v166, s11, v146
    v_add_u32 v167, 32, v166
    s_mul_i32 s12, s9, 18
    s_mov_b32 s16, s6
    s_mov_b32 s17, s7
    s_mov_b32 s18, 7133184
    s_mov_b32 s19, 0x00020000
    v_and_b32 v148, 0xfffffff3, v166
    v_and_b32 v149, 4, v166
    v_lshl_add_u32 v148, v149, 1, v148
    v_and_b32 v149, 8, v166
    v_lshrrev_b32 v149, 1, v149
    v_add_u32 v148, v148, v149
    v_lshrrev_b32 v150, 5, v148
    v_lshlrev_b32 v150, 8, v150
    v_and_b32 v149, 16, v148
    v_lshl_add_u32 v150, v149, 3, v150
    v_and_b32 v149, 15, v148
    v_lshl_add_u32 v150, v149, 1, v150
    v_mul_u32_u24 v162, 33024, v147
    v_add_u32 v162, v162, v150
    s_add_u32 s13, s12, 0
    s_and_b32 s11, s13, 3
    s_lshr_b32 s13, s13, 2
    s_mul_i32 s13, s13, 16512
    s_lshl_b32 s11, s11, 5
    s_add_u32 s13, s13, s11
    buffer_load_ushort v2, v162, s[16:19], s13 offen
    s_add_u32 s13, s12, 1
    s_and_b32 s11, s13, 3
    s_lshr_b32 s13, s13, 2
    s_mul_i32 s13, s13, 16512
    s_lshl_b32 s11, s11, 5
    s_add_u32 s13, s13, s11
    buffer_load_ushort v3, v162, s[16:19], s13 offen
    s_add_u32 s13, s12, 2
    s_and_b32 s11, s13, 3
    s_lshr_b32 s13, s13, 2
    s_mul_i32 s13, s13, 16512
    s_lshl_b32 s11, s11, 5
    s_add_u32 s13, s13, s11
    buffer_load_ushort v4, v162, s[16:19], s13 offen
    s_add_u32 s13, s12, 3
    s_and_b32 s11, s13, 3
    s_lshr_b32 s13, s13, 2
    s_mul_i32 s13, s13, 16512
    s_lshl_b32 s11, s11, 5
    s_add_u32 s13, s13, s11
    buffer_load_ushort v5, v162, s[16:19], s13 offen
    s_add_u32 s13, s12, 4
    s_and_b32 s11, s13, 3
    s_lshr_b32 s13, s13, 2
    s_mul_i32 s13, s13, 16512
    s_lshl_b32 s11, s11, 5
    s_add_u32 s13, s13, s11
    buffer_load_ushort v6, v162, s[16:19], s13 offen
    s_add_u32 s13, s12, 5
    s_and_b32 s11, s13, 3
    s_lshr_b32 s13, s13, 2
    s_mul_i32 s13, s13, 16512
    s_lshl_b32 s11, s11, 5
    s_add_u32 s13, s13, s11
    buffer_load_ushort v7, v162, s[16:19], s13 offen
    s_add_u32 s13, s12, 6
    s_and_b32 s11, s13, 3
    s_lshr_b32 s13, s13, 2
    s_mul_i32 s13, s13, 16512
    s_lshl_b32 s11, s11, 5
    s_add_u32 s13, s13, s11
    buffer_load_ushort v8, v162, s[16:19], s13 offen
    s_add_u32 s13, s12, 7
    s_and_b32 s11, s13, 3
    s_lshr_b32 s13, s13, 2
    s_mul_i32 s13, s13, 16512
    s_lshl_b32 s11, s11, 5
    s_add_u32 s13, s13, s11
    buffer_load_ushort v9, v162, s[16:19], s13 offen
    s_add_u32 s13, s12, 16
    s_and_b32 s11, s13, 3
    s_lshr_b32 s13, s13, 2
    s_mul_i32 s13, s13, 16512
    s_lshl_b32 s11, s11, 5
    s_add_u32 s13, s13, s11
    buffer_load_ushort v10, v150, s[16:19], s13 offen
    s_add_u32 s13, s12, 17
    s_and_b32 s11, s13, 3
    s_lshr_b32 s13, s13, 2
    s_mul_i32 s13, s13, 16512
    s_lshl_b32 s11, s11, 5
    s_add_u32 s13, s13, s11
    buffer_load_ushort v11, v150, s[16:19], s13 offen
    v_and_b32 v148, 0xfffffff3, v167
    v_and_b32 v149, 4, v167
    v_lshl_add_u32 v148, v149, 1, v148
    v_and_b32 v149, 8, v167
    v_lshrrev_b32 v149, 1, v149
    v_add_u32 v148, v148, v149
    v_lshrrev_b32 v150, 5, v148
    v_lshlrev_b32 v150, 8, v150
    v_and_b32 v149, 16, v148
    v_lshl_add_u32 v150, v149, 3, v150
    v_and_b32 v149, 15, v148
    v_lshl_add_u32 v150, v149, 1, v150
    v_mul_u32_u24 v162, 33024, v147
    v_add_u32 v162, v162, v150
    s_add_u32 s13, s12, 0
    s_and_b32 s11, s13, 3
    s_lshr_b32 s13, s13, 2
    s_mul_i32 s13, s13, 16512
    s_lshl_b32 s11, s11, 5
    s_add_u32 s13, s13, s11
    buffer_load_ushort v18, v162, s[16:19], s13 offen
    s_add_u32 s13, s12, 1
    s_and_b32 s11, s13, 3
    s_lshr_b32 s13, s13, 2
    s_mul_i32 s13, s13, 16512
    s_lshl_b32 s11, s11, 5
    s_add_u32 s13, s13, s11
    buffer_load_ushort v19, v162, s[16:19], s13 offen
    s_add_u32 s13, s12, 2
    s_and_b32 s11, s13, 3
    s_lshr_b32 s13, s13, 2
    s_mul_i32 s13, s13, 16512
    s_lshl_b32 s11, s11, 5
    s_add_u32 s13, s13, s11
    buffer_load_ushort v20, v162, s[16:19], s13 offen
    s_add_u32 s13, s12, 3
    s_and_b32 s11, s13, 3
    s_lshr_b32 s13, s13, 2
    s_mul_i32 s13, s13, 16512
    s_lshl_b32 s11, s11, 5
    s_add_u32 s13, s13, s11
    buffer_load_ushort v21, v162, s[16:19], s13 offen
    s_add_u32 s13, s12, 4
    s_and_b32 s11, s13, 3
    s_lshr_b32 s13, s13, 2
    s_mul_i32 s13, s13, 16512
    s_lshl_b32 s11, s11, 5
    s_add_u32 s13, s13, s11
    buffer_load_ushort v22, v162, s[16:19], s13 offen
    s_add_u32 s13, s12, 5
    s_and_b32 s11, s13, 3
    s_lshr_b32 s13, s13, 2
    s_mul_i32 s13, s13, 16512
    s_lshl_b32 s11, s11, 5
    s_add_u32 s13, s13, s11
    buffer_load_ushort v23, v162, s[16:19], s13 offen
    s_add_u32 s13, s12, 6
    s_and_b32 s11, s13, 3
    s_lshr_b32 s13, s13, 2
    s_mul_i32 s13, s13, 16512
    s_lshl_b32 s11, s11, 5
    s_add_u32 s13, s13, s11
    buffer_load_ushort v24, v162, s[16:19], s13 offen
    s_add_u32 s13, s12, 7
    s_and_b32 s11, s13, 3
    s_lshr_b32 s13, s13, 2
    s_mul_i32 s13, s13, 16512
    s_lshl_b32 s11, s11, 5
    s_add_u32 s13, s13, s11
    buffer_load_ushort v25, v162, s[16:19], s13 offen
    s_add_u32 s13, s12, 16
    s_and_b32 s11, s13, 3
    s_lshr_b32 s13, s13, 2
    s_mul_i32 s13, s13, 16512
    s_lshl_b32 s11, s11, 5
    s_add_u32 s13, s13, s11
    buffer_load_ushort v26, v150, s[16:19], s13 offen
    s_add_u32 s13, s12, 17
    s_and_b32 s11, s13, 3
    s_lshr_b32 s13, s13, 2
    s_mul_i32 s13, s13, 16512
    s_lshl_b32 s11, s11, 5
    s_add_u32 s13, s13, s11
    buffer_load_ushort v27, v150, s[16:19], s13 offen
    v_mov_b32 v108, 0
    v_mov_b32 v109, 0
    v_mov_b32 v112, 0
    v_mov_b32 v113, 0
    v_mov_b32 v91, 0
    v_mov_b32 v92, 0
    v_mov_b32 v93, 0
    v_mov_b32 v50, 0
    v_mov_b32 v51, 0
    v_mov_b32 v52, 0
    v_mov_b32 v53, 0
    v_mov_b32 v54, 0
    v_mov_b32 v55, 0
    v_mov_b32 v56, 0
    v_mov_b32 v57, 0
    v_mov_b32 v58, 0
    v_mov_b32 v59, 0
    v_mov_b32 v60, 0
    v_mov_b32 v61, 0
    v_mov_b32 v62, 0
    v_mov_b32 v63, 0
    v_mov_b32 v64, 0
    v_mov_b32 v65, 0
    v_mov_b32 v95, 0
    v_mov_b32 v96, 0
    v_mov_b32 v97, 0
    v_mov_b32 v66, 0
    v_mov_b32 v67, 0
    v_mov_b32 v68, 0
    v_mov_b32 v69, 0
    v_mov_b32 v70, 0
    v_mov_b32 v71, 0
    v_mov_b32 v72, 0
    v_mov_b32 v73, 0
    v_mov_b32 v74, 0
    v_mov_b32 v75, 0
    v_mov_b32 v76, 0
    v_mov_b32 v77, 0
    v_mov_b32 v78, 0
    v_mov_b32 v79, 0
    v_mov_b32 v80, 0
    v_mov_b32 v81, 0
    v_mov_b32 v34, 0
    v_mov_b32 v114, 0
    v_mov_b32 v35, 0
    v_mov_b32 v115, 0
    v_mov_b32 v36, 0
    v_mov_b32 v116, 0
    v_mov_b32 v37, 0
    v_mov_b32 v117, 0
    v_mov_b32 v38, 0
    v_mov_b32 v118, 0
    v_mov_b32 v39, 0
    v_mov_b32 v119, 0
    v_mov_b32 v40, 0
    v_mov_b32 v120, 0
    v_mov_b32 v41, 0
    v_mov_b32 v121, 0
    v_mov_b32 v42, 0
    v_mov_b32 v122, 0
    v_mov_b32 v43, 0
    v_mov_b32 v123, 0
    v_mov_b32 v44, 0
    v_mov_b32 v124, 0
    v_mov_b32 v45, 0
    v_mov_b32 v125, 0
    v_mov_b32 v46, 0
    v_mov_b32 v126, 0
    v_mov_b32 v47, 0
    v_mov_b32 v127, 0
    v_mov_b32 v48, 0
    v_mov_b32 v128, 0
    v_mov_b32 v49, 0
    v_mov_b32 v129, 0
    v_lshrrev_b32 v148, 2, v0
    v_and_b32 v148, 3, v148
    v_and_b32 v149, 1, v0
    v_lshlrev_b32 v149, 1, v149
    v_lshrrev_b32 v152, 1, v0
    v_and_b32 v152, 1, v152
    v_or_b32 v149, v149, v152
    v_lshrrev_b32 v150, 4, v0
    v_and_b32 v150, 1, v150
    v_lshlrev_b32 v151, 3, v149
    v_lshl_add_u32 v151, v150, 5, v151
    v_lshlrev_b32 v152, 3, v147
    v_add_u32 v152, v152, v148
    v_lshlrev_b32 v152, 8, v152
    v_add_u32 v152, 512, v152
    v_add_u32 v152, v152, v151
    v_lshlrev_b32 v153, 8, v148
    v_add_u32 v153, 4608, v153
    v_mov_b32 v154, 0
    v_cmp_lt_u32 vcc, 1, v148
    s_nop 1
    v_cndmask_b32 v153, v153, v154, vcc
    v_cmp_lt_u32 vcc, 31, v0
    v_mov_b32 v154, 256
    s_nop 0
    v_cndmask_b32 v153, v153, v154, vcc
    v_add_u32 v153, v153, v151
    v_xor_b32 v154, 0, v148
    v_lshlrev_b32 v154, 6, v154
    v_add_u32 v130, v152, v154
    v_add_u32 v134, v153, v154
    v_xor_b32 v154, 1, v148
    v_lshlrev_b32 v154, 6, v154
    v_add_u32 v131, v152, v154
    v_add_u32 v135, v153, v154
    v_xor_b32 v154, 2, v148
    v_lshlrev_b32 v154, 6, v154
    v_add_u32 v132, v152, v154
    v_add_u32 v136, v153, v154
    v_xor_b32 v154, 3, v148
    v_lshlrev_b32 v154, 6, v154
    v_add_u32 v133, v152, v154
    v_add_u32 v137, v153, v154
    v_and_b32 v150, 15, v146
    v_lshlrev_b32 v151, 8, v146
    v_add_u32 v151, 5120, v151
    v_cmp_eq_u32 vcc, 18, v146
    v_mov_b32 v148, 0
    s_nop 0
    v_cndmask_b32 v151, v151, v148, vcc
    v_cmp_lt_u32 vcc, 18, v146
    v_mov_b32 v148, 256
    v_mov_b32 v152, 3
    v_cndmask_b32 v151, v151, v148, vcc
    v_cndmask_b32 v150, v150, v152, vcc
    v_add_u32 v148, -20, v146
    v_cmp_gt_u32 vcc, 8, v148
    v_mov_b32 v152, 4
    s_nop 0
    v_cndmask_b32 v150, v150, v152, vcc
    v_xor_b32 v150, v150, v147
    v_lshlrev_b32 v150, 4, v150
    v_add_u32 v150, v150, v151
    v_xor_b32 v138, 0, v150
    v_xor_b32 v139, 32, v150
    v_xor_b32 v140, 64, v150
    v_xor_b32 v141, 96, v150
    v_xor_b32 v142, 128, v150
    v_xor_b32 v143, 160, v150
    v_xor_b32 v144, 192, v150
    v_xor_b32 v145, 224, v150
    s_mul_i32 s13, s8, 9728
    v_lshlrev_b32 v152, 2, v0
    v_add_u32 v152, s13, v152
    v_mov_b32 v153, 0x3f803f80
    v_mov_b32 v154, 0
    ds_write_b32 v152, v153 offset:0
    ds_write_b32 v152, v154 offset:256
    s_waitcnt vmcnt(0) lgkmcnt(0)
    v_lshl_or_b32 v82, v3, 16, v2
    v_lshl_or_b32 v83, v5, 16, v4
    v_lshl_or_b32 v84, v7, 16, v6
    v_lshl_or_b32 v85, v9, 16, v8
    v_lshl_or_b32 v90, v11, 16, v10
    v_lshl_or_b32 v86, v19, 16, v18
    v_lshl_or_b32 v87, v21, 16, v20
    v_lshl_or_b32 v88, v23, 16, v22
    v_lshl_or_b32 v89, v25, 16, v24
    v_lshl_or_b32 v94, v27, 16, v26
    v_cmp_gt_u32 vcc, 32, v0
    v_mov_b32 v152, 0
    s_nop 0
    v_cndmask_b32 v90, v152, v90, vcc
    v_cndmask_b32 v94, v152, v94, vcc
    s_barrier
    ds_read_b64_tr_b16 v[98:99], v130 offset:0
    ds_read_b64_tr_b16 v[100:101], v130 offset:1024
    ds_read_b64_tr_b16 v[106:107], v134 offset:0
    ds_read_b64_tr_b16 v[102:103], v131 offset:0
    ds_read_b64_tr_b16 v[104:105], v131 offset:1024
    ds_read_b64_tr_b16 v[110:111], v135 offset:0
    s_waitcnt lgkmcnt(0)
    v_mfma_f32_32x32x16_bf16 v[2:17], v[98:101], v[82:85], 0
    v_mfma_f32_32x32x16_bf16 v[2:17], v[106:109], v[90:93], v[2:17]
    v_mfma_f32_32x32x16_bf16 v[18:33], v[102:105], v[82:85], 0
    v_mfma_f32_32x32x16_bf16 v[18:33], v[110:113], v[90:93], v[18:33]
    s_nop 7
    s_nop 7
    v_max3_f32 v154, v2, v3, v4
    v_max3_f32 v154, v154, v5, v6
    v_max3_f32 v154, v154, v7, v8
    v_max3_f32 v154, v154, v9, v10
    v_max3_f32 v154, v154, v11, v12
    v_max3_f32 v154, v154, v13, v14
    v_max3_f32 v154, v154, v15, v16
    v_max3_f32 v154, v154, v17, v18
    v_max3_f32 v154, v154, v19, v20
    v_max3_f32 v154, v154, v21, v22
    v_max3_f32 v154, v154, v23, v24
    v_max3_f32 v154, v154, v25, v26
    v_max3_f32 v154, v154, v27, v28
    v_max3_f32 v154, v154, v29, v30
    v_max3_f32 v154, v154, v31, v32
    v_max_f32 v154, v154, v33
    v_mfma_f32_32x32x16_bf16 v[2:17], v[98:101], v[86:89], 0
    v_mfma_f32_32x32x16_bf16 v[2:17], v[106:109], v[94:97], v[2:17]
    v_mfma_f32_32x32x16_bf16 v[18:33], v[102:105], v[86:89], 0
    v_mfma_f32_32x32x16_bf16 v[18:33], v[110:113], v[94:97], v[18:33]
    s_nop 7
    s_nop 7
    v_max3_f32 v155, v2, v3, v4
    v_max3_f32 v155, v155, v5, v6
    v_max3_f32 v155, v155, v7, v8
    v_max3_f32 v155, v155, v9, v10
    v_max3_f32 v155, v155, v11, v12
    v_max3_f32 v155, v155, v13, v14
    v_max3_f32 v155, v155, v15, v16
    v_max3_f32 v155, v155, v17, v18
    v_max3_f32 v155, v155, v19, v20
    v_max3_f32 v155, v155, v21, v22
    v_max3_f32 v155, v155, v23, v24
    v_max3_f32 v155, v155, v25, v26
    v_max3_f32 v155, v155, v27, v28
    v_max3_f32 v155, v155, v29, v30
    v_max3_f32 v155, v155, v31, v32
    v_max_f32 v155, v155, v33
K2_SETM:
    v_mov_b32 v156, v154
    s_nop 1
    v_permlane32_swap_b32 v154, v156
    s_nop 1
    v_max_f32 v156, v154, v156
    v_add_f32 v156, 0x42b00000, v156
    v_sub_f32 v156, 0, v156
    v_cvt_pk_bf16_f32 v157, v156, v156
    v_lshlrev_b32 v158, 16, v157
    v_sub_f32 v158, v156, v158
    v_cvt_pk_bf16_f32 v156, v156, v158
    v_cmp_gt_u32 vcc, 32, v0
    v_mov_b32 v157, 0
    s_nop 0
    v_cndmask_b32 v91, v157, v156, vcc
    v_mov_b32 v156, v155
    s_nop 1
    v_permlane32_swap_b32 v155, v156
    s_nop 1
    v_max_f32 v156, v155, v156
    v_add_f32 v156, 0x42b00000, v156
    v_sub_f32 v156, 0, v156
    v_cvt_pk_bf16_f32 v157, v156, v156
    v_lshlrev_b32 v158, 16, v157
    v_sub_f32 v158, v156, v158
    v_cvt_pk_bf16_f32 v156, v156, v158
    v_cmp_gt_u32 vcc, 32, v0
    v_mov_b32 v157, 0
    s_nop 0
    v_cndmask_b32 v95, v157, v156, vcc
    s_nop 1
    v_mfma_f32_32x32x16_bf16 v[2:17], v[98:101], v[82:85], 0
    v_mfma_f32_32x32x16_bf16 v[2:17], v[106:109], v[90:93], v[2:17]
    s_barrier
    s_nop 7
    s_nop 3
    s_mov_b32 s32, 0
K2_ALOOP:
    v_mfma_f32_32x32x16_bf16 v[18:33], v[98:101], v[86:89], 0
    ds_read_b64_tr_b16 v[102:103], v131 offset:0
    ds_read_b64_tr_b16 v[104:105], v131 offset:1024
    ds_read_b64_tr_b16 v[110:111], v135 offset:0
    v_exp_f32 v2, v2
    v_exp_f32 v3, v3
    v_exp_f32 v4, v4
    v_exp_f32 v5, v5
    v_cvt_pk_bf16_f32 v34, v2, v3
    v_cvt_pk_bf16_f32 v35, v4, v5
    v_mfma_f32_32x32x16_bf16 v[18:33], v[106:109], v[94:97], v[18:33]
    ds_read_b128 v[114:117], v138 offset:0
    ds_read_b128 v[118:121], v139 offset:0
    v_exp_f32 v6, v6
    v_exp_f32 v7, v7
    v_exp_f32 v8, v8
    v_exp_f32 v9, v9
    v_cvt_pk_bf16_f32 v36, v6, v7
    v_cvt_pk_bf16_f32 v37, v8, v9
    v_mfma_f32_32x32x16_bf16 v[66:81], v[122:125], v[42:45], v[66:81]
    v_exp_f32 v10, v10
    v_exp_f32 v11, v11
    v_exp_f32 v12, v12
    v_exp_f32 v13, v13
    v_cvt_pk_bf16_f32 v38, v10, v11
    v_cvt_pk_bf16_f32 v39, v12, v13
    v_mfma_f32_32x32x16_bf16 v[66:81], v[126:129], v[46:49], v[66:81]
    v_exp_f32 v14, v14
    v_exp_f32 v15, v15
    v_exp_f32 v16, v16
    v_exp_f32 v17, v17
    v_cvt_pk_bf16_f32 v40, v14, v15
    v_cvt_pk_bf16_f32 v41, v16, v17
    s_waitcnt lgkmcnt(0)
    v_mfma_f32_32x32x16_bf16 v[2:17], v[102:105], v[82:85], 0
    v_exp_f32 v18, v18
    v_exp_f32 v19, v19
    v_exp_f32 v20, v20
    v_exp_f32 v21, v21
    v_cvt_pk_bf16_f32 v42, v18, v19
    v_cvt_pk_bf16_f32 v43, v20, v21
    v_mfma_f32_32x32x16_bf16 v[2:17], v[110:113], v[90:93], v[2:17]
    v_exp_f32 v22, v22
    v_exp_f32 v23, v23
    v_exp_f32 v24, v24
    v_exp_f32 v25, v25
    v_cvt_pk_bf16_f32 v44, v22, v23
    v_cvt_pk_bf16_f32 v45, v24, v25
    v_mfma_f32_32x32x16_bf16 v[50:65], v[114:117], v[34:37], v[50:65]
    v_exp_f32 v26, v26
    v_exp_f32 v27, v27
    v_exp_f32 v28, v28
    v_exp_f32 v29, v29
    v_cvt_pk_bf16_f32 v46, v26, v27
    v_cvt_pk_bf16_f32 v47, v28, v29
    v_mfma_f32_32x32x16_bf16 v[50:65], v[118:121], v[38:41], v[50:65]
    v_exp_f32 v30, v30
    v_exp_f32 v31, v31
    v_exp_f32 v32, v32
    v_exp_f32 v33, v33
    v_cvt_pk_bf16_f32 v48, v30, v31
    v_cvt_pk_bf16_f32 v49, v32, v33
    v_mfma_f32_32x32x16_bf16 v[18:33], v[102:105], v[86:89], 0
    ds_read_b64_tr_b16 v[98:99], v132 offset:0
    ds_read_b64_tr_b16 v[100:101], v132 offset:1024
    ds_read_b64_tr_b16 v[106:107], v136 offset:0
    v_exp_f32 v2, v2
    v_exp_f32 v3, v3
    v_exp_f32 v4, v4
    v_exp_f32 v5, v5
    v_cvt_pk_bf16_f32 v34, v2, v3
    v_cvt_pk_bf16_f32 v35, v4, v5
    v_mfma_f32_32x32x16_bf16 v[18:33], v[110:113], v[94:97], v[18:33]
    ds_read_b128 v[122:125], v140 offset:0
    ds_read_b128 v[126:129], v141 offset:0
    v_exp_f32 v6, v6
    v_exp_f32 v7, v7
    v_exp_f32 v8, v8
    v_exp_f32 v9, v9
    v_cvt_pk_bf16_f32 v36, v6, v7
    v_cvt_pk_bf16_f32 v37, v8, v9
    v_mfma_f32_32x32x16_bf16 v[66:81], v[114:117], v[42:45], v[66:81]
    v_exp_f32 v10, v10
    v_exp_f32 v11, v11
    v_exp_f32 v12, v12
    v_exp_f32 v13, v13
    v_cvt_pk_bf16_f32 v38, v10, v11
    v_cvt_pk_bf16_f32 v39, v12, v13
    v_mfma_f32_32x32x16_bf16 v[66:81], v[118:121], v[46:49], v[66:81]
    v_exp_f32 v14, v14
    v_exp_f32 v15, v15
    v_exp_f32 v16, v16
    v_exp_f32 v17, v17
    v_cvt_pk_bf16_f32 v40, v14, v15
    v_cvt_pk_bf16_f32 v41, v16, v17
    s_waitcnt lgkmcnt(0)
    v_mfma_f32_32x32x16_bf16 v[2:17], v[98:101], v[82:85], 0
    v_exp_f32 v18, v18
    v_exp_f32 v19, v19
    v_exp_f32 v20, v20
    v_exp_f32 v21, v21
    v_cvt_pk_bf16_f32 v42, v18, v19
    v_cvt_pk_bf16_f32 v43, v20, v21
    v_mfma_f32_32x32x16_bf16 v[2:17], v[106:109], v[90:93], v[2:17]
    v_exp_f32 v22, v22
    v_exp_f32 v23, v23
    v_exp_f32 v24, v24
    v_exp_f32 v25, v25
    v_cvt_pk_bf16_f32 v44, v22, v23
    v_cvt_pk_bf16_f32 v45, v24, v25
    v_mfma_f32_32x32x16_bf16 v[50:65], v[122:125], v[34:37], v[50:65]
    v_exp_f32 v26, v26
    v_exp_f32 v27, v27
    v_exp_f32 v28, v28
    v_exp_f32 v29, v29
    v_cvt_pk_bf16_f32 v46, v26, v27
    v_cvt_pk_bf16_f32 v47, v28, v29
    v_mfma_f32_32x32x16_bf16 v[50:65], v[126:129], v[38:41], v[50:65]
    v_exp_f32 v30, v30
    v_exp_f32 v31, v31
    v_exp_f32 v32, v32
    v_exp_f32 v33, v33
    v_cvt_pk_bf16_f32 v48, v30, v31
    v_cvt_pk_bf16_f32 v49, v32, v33
    v_mfma_f32_32x32x16_bf16 v[18:33], v[98:101], v[86:89], 0
    ds_read_b64_tr_b16 v[102:103], v133 offset:0
    ds_read_b64_tr_b16 v[104:105], v133 offset:1024
    ds_read_b64_tr_b16 v[110:111], v137 offset:0
    v_exp_f32 v2, v2
    v_exp_f32 v3, v3
    v_exp_f32 v4, v4
    v_exp_f32 v5, v5
    v_cvt_pk_bf16_f32 v34, v2, v3
    v_cvt_pk_bf16_f32 v35, v4, v5
    v_mfma_f32_32x32x16_bf16 v[18:33], v[106:109], v[94:97], v[18:33]
    ds_read_b128 v[114:117], v142 offset:0
    ds_read_b128 v[118:121], v143 offset:0
    v_exp_f32 v6, v6
    v_exp_f32 v7, v7
    v_exp_f32 v8, v8
    v_exp_f32 v9, v9
    v_cvt_pk_bf16_f32 v36, v6, v7
    v_cvt_pk_bf16_f32 v37, v8, v9
    v_mfma_f32_32x32x16_bf16 v[66:81], v[122:125], v[42:45], v[66:81]
    v_exp_f32 v10, v10
    v_exp_f32 v11, v11
    v_exp_f32 v12, v12
    v_exp_f32 v13, v13
    v_cvt_pk_bf16_f32 v38, v10, v11
    v_cvt_pk_bf16_f32 v39, v12, v13
    v_mfma_f32_32x32x16_bf16 v[66:81], v[126:129], v[46:49], v[66:81]
    v_exp_f32 v14, v14
    v_exp_f32 v15, v15
    v_exp_f32 v16, v16
    v_exp_f32 v17, v17
    v_cvt_pk_bf16_f32 v40, v14, v15
    v_cvt_pk_bf16_f32 v41, v16, v17
    s_waitcnt lgkmcnt(0)
    v_mfma_f32_32x32x16_bf16 v[2:17], v[102:105], v[82:85], 0
    v_exp_f32 v18, v18
    v_exp_f32 v19, v19
    v_exp_f32 v20, v20
    v_exp_f32 v21, v21
    v_cvt_pk_bf16_f32 v42, v18, v19
    v_cvt_pk_bf16_f32 v43, v20, v21
    v_mfma_f32_32x32x16_bf16 v[2:17], v[110:113], v[90:93], v[2:17]
    v_exp_f32 v22, v22
    v_exp_f32 v23, v23
    v_exp_f32 v24, v24
    v_exp_f32 v25, v25
    v_cvt_pk_bf16_f32 v44, v22, v23
    v_cvt_pk_bf16_f32 v45, v24, v25
    v_mfma_f32_32x32x16_bf16 v[50:65], v[114:117], v[34:37], v[50:65]
    v_exp_f32 v26, v26
    v_exp_f32 v27, v27
    v_exp_f32 v28, v28
    v_exp_f32 v29, v29
    v_cvt_pk_bf16_f32 v46, v26, v27
    v_cvt_pk_bf16_f32 v47, v28, v29
    v_mfma_f32_32x32x16_bf16 v[50:65], v[118:121], v[38:41], v[50:65]
    v_exp_f32 v30, v30
    v_exp_f32 v31, v31
    v_exp_f32 v32, v32
    v_exp_f32 v33, v33
    v_cvt_pk_bf16_f32 v48, v30, v31
    v_cvt_pk_bf16_f32 v49, v32, v33
    v_mfma_f32_32x32x16_bf16 v[18:33], v[102:105], v[86:89], 0
    ds_read_b64_tr_b16 v[98:99], v130 offset:9728
    ds_read_b64_tr_b16 v[100:101], v130 offset:10752
    ds_read_b64_tr_b16 v[106:107], v134 offset:9728
    v_exp_f32 v2, v2
    v_exp_f32 v3, v3
    v_exp_f32 v4, v4
    v_exp_f32 v5, v5
    v_cvt_pk_bf16_f32 v34, v2, v3
    v_cvt_pk_bf16_f32 v35, v4, v5
    v_mfma_f32_32x32x16_bf16 v[18:33], v[110:113], v[94:97], v[18:33]
    ds_read_b128 v[122:125], v144 offset:0
    ds_read_b128 v[126:129], v145 offset:0
    v_exp_f32 v6, v6
    v_exp_f32 v7, v7
    v_exp_f32 v8, v8
    v_exp_f32 v9, v9
    v_cvt_pk_bf16_f32 v36, v6, v7
    v_cvt_pk_bf16_f32 v37, v8, v9
    v_mfma_f32_32x32x16_bf16 v[66:81], v[114:117], v[42:45], v[66:81]
    v_exp_f32 v10, v10
    v_exp_f32 v11, v11
    v_exp_f32 v12, v12
    v_exp_f32 v13, v13
    v_cvt_pk_bf16_f32 v38, v10, v11
    v_cvt_pk_bf16_f32 v39, v12, v13
    v_mfma_f32_32x32x16_bf16 v[66:81], v[118:121], v[46:49], v[66:81]
    v_exp_f32 v14, v14
    v_exp_f32 v15, v15
    v_exp_f32 v16, v16
    v_exp_f32 v17, v17
    v_cvt_pk_bf16_f32 v40, v14, v15
    v_cvt_pk_bf16_f32 v41, v16, v17
    s_waitcnt lgkmcnt(0)
    s_barrier
    v_mfma_f32_32x32x16_bf16 v[2:17], v[98:101], v[82:85], 0
    v_exp_f32 v18, v18
    v_exp_f32 v19, v19
    v_exp_f32 v20, v20
    v_exp_f32 v21, v21
    v_cvt_pk_bf16_f32 v42, v18, v19
    v_cvt_pk_bf16_f32 v43, v20, v21
    v_mfma_f32_32x32x16_bf16 v[2:17], v[106:109], v[90:93], v[2:17]
    v_exp_f32 v22, v22
    v_exp_f32 v23, v23
    v_exp_f32 v24, v24
    v_exp_f32 v25, v25
    v_cvt_pk_bf16_f32 v44, v22, v23
    v_cvt_pk_bf16_f32 v45, v24, v25
    v_mfma_f32_32x32x16_bf16 v[50:65], v[122:125], v[34:37], v[50:65]
    v_exp_f32 v26, v26
    v_exp_f32 v27, v27
    v_exp_f32 v28, v28
    v_exp_f32 v29, v29
    v_cvt_pk_bf16_f32 v46, v26, v27
    v_cvt_pk_bf16_f32 v47, v28, v29
    v_mfma_f32_32x32x16_bf16 v[50:65], v[126:129], v[38:41], v[50:65]
    v_exp_f32 v30, v30
    v_exp_f32 v31, v31
    v_exp_f32 v32, v32
    v_exp_f32 v33, v33
    v_cvt_pk_bf16_f32 v48, v30, v31
    v_cvt_pk_bf16_f32 v49, v32, v33
    v_mfma_f32_32x32x16_bf16 v[18:33], v[98:101], v[86:89], 0
    ds_read_b64_tr_b16 v[102:103], v131 offset:9728
    ds_read_b64_tr_b16 v[104:105], v131 offset:10752
    ds_read_b64_tr_b16 v[110:111], v135 offset:9728
    v_exp_f32 v2, v2
    v_exp_f32 v3, v3
    v_exp_f32 v4, v4
    v_exp_f32 v5, v5
    v_cvt_pk_bf16_f32 v34, v2, v3
    v_cvt_pk_bf16_f32 v35, v4, v5
    v_mfma_f32_32x32x16_bf16 v[18:33], v[106:109], v[94:97], v[18:33]
    ds_read_b128 v[114:117], v138 offset:9728
    ds_read_b128 v[118:121], v139 offset:9728
    v_exp_f32 v6, v6
    v_exp_f32 v7, v7
    v_exp_f32 v8, v8
    v_exp_f32 v9, v9
    v_cvt_pk_bf16_f32 v36, v6, v7
    v_cvt_pk_bf16_f32 v37, v8, v9
    v_mfma_f32_32x32x16_bf16 v[66:81], v[122:125], v[42:45], v[66:81]
    v_exp_f32 v10, v10
    v_exp_f32 v11, v11
    v_exp_f32 v12, v12
    v_exp_f32 v13, v13
    v_cvt_pk_bf16_f32 v38, v10, v11
    v_cvt_pk_bf16_f32 v39, v12, v13
    v_mfma_f32_32x32x16_bf16 v[66:81], v[126:129], v[46:49], v[66:81]
    v_exp_f32 v14, v14
    v_exp_f32 v15, v15
    v_exp_f32 v16, v16
    v_exp_f32 v17, v17
    v_cvt_pk_bf16_f32 v40, v14, v15
    v_cvt_pk_bf16_f32 v41, v16, v17
    s_waitcnt lgkmcnt(0)
    v_mfma_f32_32x32x16_bf16 v[2:17], v[102:105], v[82:85], 0
    v_exp_f32 v18, v18
    v_exp_f32 v19, v19
    v_exp_f32 v20, v20
    v_exp_f32 v21, v21
    v_cvt_pk_bf16_f32 v42, v18, v19
    v_cvt_pk_bf16_f32 v43, v20, v21
    v_mfma_f32_32x32x16_bf16 v[2:17], v[110:113], v[90:93], v[2:17]
    v_exp_f32 v22, v22
    v_exp_f32 v23, v23
    v_exp_f32 v24, v24
    v_exp_f32 v25, v25
    v_cvt_pk_bf16_f32 v44, v22, v23
    v_cvt_pk_bf16_f32 v45, v24, v25
    v_mfma_f32_32x32x16_bf16 v[50:65], v[114:117], v[34:37], v[50:65]
    v_exp_f32 v26, v26
    v_exp_f32 v27, v27
    v_exp_f32 v28, v28
    v_exp_f32 v29, v29
    v_cvt_pk_bf16_f32 v46, v26, v27
    v_cvt_pk_bf16_f32 v47, v28, v29
    v_mfma_f32_32x32x16_bf16 v[50:65], v[118:121], v[38:41], v[50:65]
    v_exp_f32 v30, v30
    v_exp_f32 v31, v31
    v_exp_f32 v32, v32
    v_exp_f32 v33, v33
    v_cvt_pk_bf16_f32 v48, v30, v31
    v_cvt_pk_bf16_f32 v49, v32, v33
    v_mfma_f32_32x32x16_bf16 v[18:33], v[102:105], v[86:89], 0
    ds_read_b64_tr_b16 v[98:99], v132 offset:9728
    ds_read_b64_tr_b16 v[100:101], v132 offset:10752
    ds_read_b64_tr_b16 v[106:107], v136 offset:9728
    v_exp_f32 v2, v2
    v_exp_f32 v3, v3
    v_exp_f32 v4, v4
    v_exp_f32 v5, v5
    v_cvt_pk_bf16_f32 v34, v2, v3
    v_cvt_pk_bf16_f32 v35, v4, v5
    v_mfma_f32_32x32x16_bf16 v[18:33], v[110:113], v[94:97], v[18:33]
    ds_read_b128 v[122:125], v140 offset:9728
    ds_read_b128 v[126:129], v141 offset:9728
    v_exp_f32 v6, v6
    v_exp_f32 v7, v7
    v_exp_f32 v8, v8
    v_exp_f32 v9, v9
    v_cvt_pk_bf16_f32 v36, v6, v7
    v_cvt_pk_bf16_f32 v37, v8, v9
    v_mfma_f32_32x32x16_bf16 v[66:81], v[114:117], v[42:45], v[66:81]
    v_exp_f32 v10, v10
    v_exp_f32 v11, v11
    v_exp_f32 v12, v12
    v_exp_f32 v13, v13
    v_cvt_pk_bf16_f32 v38, v10, v11
    v_cvt_pk_bf16_f32 v39, v12, v13
    v_mfma_f32_32x32x16_bf16 v[66:81], v[118:121], v[46:49], v[66:81]
    v_exp_f32 v14, v14
    v_exp_f32 v15, v15
    v_exp_f32 v16, v16
    v_exp_f32 v17, v17
    v_cvt_pk_bf16_f32 v40, v14, v15
    v_cvt_pk_bf16_f32 v41, v16, v17
    s_waitcnt lgkmcnt(0)
    v_mfma_f32_32x32x16_bf16 v[2:17], v[98:101], v[82:85], 0
    v_exp_f32 v18, v18
    v_exp_f32 v19, v19
    v_exp_f32 v20, v20
    v_exp_f32 v21, v21
    v_cvt_pk_bf16_f32 v42, v18, v19
    v_cvt_pk_bf16_f32 v43, v20, v21
    v_mfma_f32_32x32x16_bf16 v[2:17], v[106:109], v[90:93], v[2:17]
    v_exp_f32 v22, v22
    v_exp_f32 v23, v23
    v_exp_f32 v24, v24
    v_exp_f32 v25, v25
    v_cvt_pk_bf16_f32 v44, v22, v23
    v_cvt_pk_bf16_f32 v45, v24, v25
    v_mfma_f32_32x32x16_bf16 v[50:65], v[122:125], v[34:37], v[50:65]
    v_exp_f32 v26, v26
    v_exp_f32 v27, v27
    v_exp_f32 v28, v28
    v_exp_f32 v29, v29
    v_cvt_pk_bf16_f32 v46, v26, v27
    v_cvt_pk_bf16_f32 v47, v28, v29
    v_mfma_f32_32x32x16_bf16 v[50:65], v[126:129], v[38:41], v[50:65]
    v_exp_f32 v30, v30
    v_exp_f32 v31, v31
    v_exp_f32 v32, v32
    v_exp_f32 v33, v33
    v_cvt_pk_bf16_f32 v48, v30, v31
    v_cvt_pk_bf16_f32 v49, v32, v33
    v_mfma_f32_32x32x16_bf16 v[18:33], v[98:101], v[86:89], 0
    ds_read_b64_tr_b16 v[102:103], v133 offset:9728
    ds_read_b64_tr_b16 v[104:105], v133 offset:10752
    ds_read_b64_tr_b16 v[110:111], v137 offset:9728
    v_exp_f32 v2, v2
    v_exp_f32 v3, v3
    v_exp_f32 v4, v4
    v_exp_f32 v5, v5
    v_cvt_pk_bf16_f32 v34, v2, v3
    v_cvt_pk_bf16_f32 v35, v4, v5
    v_mfma_f32_32x32x16_bf16 v[18:33], v[106:109], v[94:97], v[18:33]
    ds_read_b128 v[114:117], v142 offset:9728
    ds_read_b128 v[118:121], v143 offset:9728
    v_exp_f32 v6, v6
    v_exp_f32 v7, v7
    v_exp_f32 v8, v8
    v_exp_f32 v9, v9
    v_cvt_pk_bf16_f32 v36, v6, v7
    v_cvt_pk_bf16_f32 v37, v8, v9
    v_mfma_f32_32x32x16_bf16 v[66:81], v[122:125], v[42:45], v[66:81]
    v_exp_f32 v10, v10
    v_exp_f32 v11, v11
    v_exp_f32 v12, v12
    v_exp_f32 v13, v13
    v_cvt_pk_bf16_f32 v38, v10, v11
    v_cvt_pk_bf16_f32 v39, v12, v13
    v_mfma_f32_32x32x16_bf16 v[66:81], v[126:129], v[46:49], v[66:81]
    v_exp_f32 v14, v14
    v_exp_f32 v15, v15
    v_exp_f32 v16, v16
    v_exp_f32 v17, v17
    v_cvt_pk_bf16_f32 v40, v14, v15
    v_cvt_pk_bf16_f32 v41, v16, v17
    s_waitcnt lgkmcnt(0)
    v_mfma_f32_32x32x16_bf16 v[2:17], v[102:105], v[82:85], 0
    v_exp_f32 v18, v18
    v_exp_f32 v19, v19
    v_exp_f32 v20, v20
    v_exp_f32 v21, v21
    v_cvt_pk_bf16_f32 v42, v18, v19
    v_cvt_pk_bf16_f32 v43, v20, v21
    v_mfma_f32_32x32x16_bf16 v[2:17], v[110:113], v[90:93], v[2:17]
    v_exp_f32 v22, v22
    v_exp_f32 v23, v23
    v_exp_f32 v24, v24
    v_exp_f32 v25, v25
    v_cvt_pk_bf16_f32 v44, v22, v23
    v_cvt_pk_bf16_f32 v45, v24, v25
    v_mfma_f32_32x32x16_bf16 v[50:65], v[114:117], v[34:37], v[50:65]
    v_exp_f32 v26, v26
    v_exp_f32 v27, v27
    v_exp_f32 v28, v28
    v_exp_f32 v29, v29
    v_cvt_pk_bf16_f32 v46, v26, v27
    v_cvt_pk_bf16_f32 v47, v28, v29
    v_mfma_f32_32x32x16_bf16 v[50:65], v[118:121], v[38:41], v[50:65]
    v_exp_f32 v30, v30
    v_exp_f32 v31, v31
    v_exp_f32 v32, v32
    v_exp_f32 v33, v33
    v_cvt_pk_bf16_f32 v48, v30, v31
    v_cvt_pk_bf16_f32 v49, v32, v33
    v_mfma_f32_32x32x16_bf16 v[18:33], v[102:105], v[86:89], 0
    ds_read_b64_tr_b16 v[98:99], v130 offset:19456
    ds_read_b64_tr_b16 v[100:101], v130 offset:20480
    ds_read_b64_tr_b16 v[106:107], v134 offset:19456
    v_exp_f32 v2, v2
    v_exp_f32 v3, v3
    v_exp_f32 v4, v4
    v_exp_f32 v5, v5
    v_cvt_pk_bf16_f32 v34, v2, v3
    v_cvt_pk_bf16_f32 v35, v4, v5
    v_mfma_f32_32x32x16_bf16 v[18:33], v[110:113], v[94:97], v[18:33]
    ds_read_b128 v[122:125], v144 offset:9728
    ds_read_b128 v[126:129], v145 offset:9728
    v_exp_f32 v6, v6
    v_exp_f32 v7, v7
    v_exp_f32 v8, v8
    v_exp_f32 v9, v9
    v_cvt_pk_bf16_f32 v36, v6, v7
    v_cvt_pk_bf16_f32 v37, v8, v9
    v_mfma_f32_32x32x16_bf16 v[66:81], v[114:117], v[42:45], v[66:81]
    v_exp_f32 v10, v10
    v_exp_f32 v11, v11
    v_exp_f32 v12, v12
    v_exp_f32 v13, v13
    v_cvt_pk_bf16_f32 v38, v10, v11
    v_cvt_pk_bf16_f32 v39, v12, v13
    v_mfma_f32_32x32x16_bf16 v[66:81], v[118:121], v[46:49], v[66:81]
    v_exp_f32 v14, v14
    v_exp_f32 v15, v15
    v_exp_f32 v16, v16
    v_exp_f32 v17, v17
    v_cvt_pk_bf16_f32 v40, v14, v15
    v_cvt_pk_bf16_f32 v41, v16, v17
    s_waitcnt lgkmcnt(0)
    s_barrier
    v_mfma_f32_32x32x16_bf16 v[2:17], v[98:101], v[82:85], 0
    v_exp_f32 v18, v18
    v_exp_f32 v19, v19
    v_exp_f32 v20, v20
    v_exp_f32 v21, v21
    v_cvt_pk_bf16_f32 v42, v18, v19
    v_cvt_pk_bf16_f32 v43, v20, v21
    v_mfma_f32_32x32x16_bf16 v[2:17], v[106:109], v[90:93], v[2:17]
    v_exp_f32 v22, v22
    v_exp_f32 v23, v23
    v_exp_f32 v24, v24
    v_exp_f32 v25, v25
    v_cvt_pk_bf16_f32 v44, v22, v23
    v_cvt_pk_bf16_f32 v45, v24, v25
    v_mfma_f32_32x32x16_bf16 v[50:65], v[122:125], v[34:37], v[50:65]
    v_exp_f32 v26, v26
    v_exp_f32 v27, v27
    v_exp_f32 v28, v28
    v_exp_f32 v29, v29
    v_cvt_pk_bf16_f32 v46, v26, v27
    v_cvt_pk_bf16_f32 v47, v28, v29
    v_mfma_f32_32x32x16_bf16 v[50:65], v[126:129], v[38:41], v[50:65]
    v_exp_f32 v30, v30
    v_exp_f32 v31, v31
    v_exp_f32 v32, v32
    v_exp_f32 v33, v33
    v_cvt_pk_bf16_f32 v48, v30, v31
    v_cvt_pk_bf16_f32 v49, v32, v33
    v_mfma_f32_32x32x16_bf16 v[18:33], v[98:101], v[86:89], 0
    ds_read_b64_tr_b16 v[102:103], v131 offset:19456
    ds_read_b64_tr_b16 v[104:105], v131 offset:20480
    ds_read_b64_tr_b16 v[110:111], v135 offset:19456
    v_exp_f32 v2, v2
    v_exp_f32 v3, v3
    v_exp_f32 v4, v4
    v_exp_f32 v5, v5
    v_cvt_pk_bf16_f32 v34, v2, v3
    v_cvt_pk_bf16_f32 v35, v4, v5
    v_mfma_f32_32x32x16_bf16 v[18:33], v[106:109], v[94:97], v[18:33]
    ds_read_b128 v[114:117], v138 offset:19456
    ds_read_b128 v[118:121], v139 offset:19456
    v_exp_f32 v6, v6
    v_exp_f32 v7, v7
    v_exp_f32 v8, v8
    v_exp_f32 v9, v9
    v_cvt_pk_bf16_f32 v36, v6, v7
    v_cvt_pk_bf16_f32 v37, v8, v9
    v_mfma_f32_32x32x16_bf16 v[66:81], v[122:125], v[42:45], v[66:81]
    v_exp_f32 v10, v10
    v_exp_f32 v11, v11
    v_exp_f32 v12, v12
    v_exp_f32 v13, v13
    v_cvt_pk_bf16_f32 v38, v10, v11
    v_cvt_pk_bf16_f32 v39, v12, v13
    v_mfma_f32_32x32x16_bf16 v[66:81], v[126:129], v[46:49], v[66:81]
    v_exp_f32 v14, v14
    v_exp_f32 v15, v15
    v_exp_f32 v16, v16
    v_exp_f32 v17, v17
    v_cvt_pk_bf16_f32 v40, v14, v15
    v_cvt_pk_bf16_f32 v41, v16, v17
    s_waitcnt lgkmcnt(0)
    v_mfma_f32_32x32x16_bf16 v[2:17], v[102:105], v[82:85], 0
    v_exp_f32 v18, v18
    v_exp_f32 v19, v19
    v_exp_f32 v20, v20
    v_exp_f32 v21, v21
    v_cvt_pk_bf16_f32 v42, v18, v19
    v_cvt_pk_bf16_f32 v43, v20, v21
    v_mfma_f32_32x32x16_bf16 v[2:17], v[110:113], v[90:93], v[2:17]
    v_exp_f32 v22, v22
    v_exp_f32 v23, v23
    v_exp_f32 v24, v24
    v_exp_f32 v25, v25
    v_cvt_pk_bf16_f32 v44, v22, v23
    v_cvt_pk_bf16_f32 v45, v24, v25
    v_mfma_f32_32x32x16_bf16 v[50:65], v[114:117], v[34:37], v[50:65]
    v_exp_f32 v26, v26
    v_exp_f32 v27, v27
    v_exp_f32 v28, v28
    v_exp_f32 v29, v29
    v_cvt_pk_bf16_f32 v46, v26, v27
    v_cvt_pk_bf16_f32 v47, v28, v29
    v_mfma_f32_32x32x16_bf16 v[50:65], v[118:121], v[38:41], v[50:65]
    v_exp_f32 v30, v30
    v_exp_f32 v31, v31
    v_exp_f32 v32, v32
    v_exp_f32 v33, v33
    v_cvt_pk_bf16_f32 v48, v30, v31
    v_cvt_pk_bf16_f32 v49, v32, v33
    v_mfma_f32_32x32x16_bf16 v[18:33], v[102:105], v[86:89], 0
    ds_read_b64_tr_b16 v[98:99], v132 offset:19456
    ds_read_b64_tr_b16 v[100:101], v132 offset:20480
    ds_read_b64_tr_b16 v[106:107], v136 offset:19456
    v_exp_f32 v2, v2
    v_exp_f32 v3, v3
    v_exp_f32 v4, v4
    v_exp_f32 v5, v5
    v_cvt_pk_bf16_f32 v34, v2, v3
    v_cvt_pk_bf16_f32 v35, v4, v5
    v_mfma_f32_32x32x16_bf16 v[18:33], v[110:113], v[94:97], v[18:33]
    ds_read_b128 v[122:125], v140 offset:19456
    ds_read_b128 v[126:129], v141 offset:19456
    v_exp_f32 v6, v6
    v_exp_f32 v7, v7
    v_exp_f32 v8, v8
    v_exp_f32 v9, v9
    v_cvt_pk_bf16_f32 v36, v6, v7
    v_cvt_pk_bf16_f32 v37, v8, v9
    v_mfma_f32_32x32x16_bf16 v[66:81], v[114:117], v[42:45], v[66:81]
    v_exp_f32 v10, v10
    v_exp_f32 v11, v11
    v_exp_f32 v12, v12
    v_exp_f32 v13, v13
    v_cvt_pk_bf16_f32 v38, v10, v11
    v_cvt_pk_bf16_f32 v39, v12, v13
    v_mfma_f32_32x32x16_bf16 v[66:81], v[118:121], v[46:49], v[66:81]
    v_exp_f32 v14, v14
    v_exp_f32 v15, v15
    v_exp_f32 v16, v16
    v_exp_f32 v17, v17
    v_cvt_pk_bf16_f32 v40, v14, v15
    v_cvt_pk_bf16_f32 v41, v16, v17
    s_waitcnt lgkmcnt(0)
    v_mfma_f32_32x32x16_bf16 v[2:17], v[98:101], v[82:85], 0
    v_exp_f32 v18, v18
    v_exp_f32 v19, v19
    v_exp_f32 v20, v20
    v_exp_f32 v21, v21
    v_cvt_pk_bf16_f32 v42, v18, v19
    v_cvt_pk_bf16_f32 v43, v20, v21
    v_mfma_f32_32x32x16_bf16 v[2:17], v[106:109], v[90:93], v[2:17]
    v_exp_f32 v22, v22
    v_exp_f32 v23, v23
    v_exp_f32 v24, v24
    v_exp_f32 v25, v25
    v_cvt_pk_bf16_f32 v44, v22, v23
    v_cvt_pk_bf16_f32 v45, v24, v25
    v_mfma_f32_32x32x16_bf16 v[50:65], v[122:125], v[34:37], v[50:65]
    v_exp_f32 v26, v26
    v_exp_f32 v27, v27
    v_exp_f32 v28, v28
    v_exp_f32 v29, v29
    v_cvt_pk_bf16_f32 v46, v26, v27
    v_cvt_pk_bf16_f32 v47, v28, v29
    v_mfma_f32_32x32x16_bf16 v[50:65], v[126:129], v[38:41], v[50:65]
    v_exp_f32 v30, v30
    v_exp_f32 v31, v31
    v_exp_f32 v32, v32
    v_exp_f32 v33, v33
    v_cvt_pk_bf16_f32 v48, v30, v31
    v_cvt_pk_bf16_f32 v49, v32, v33
    v_mfma_f32_32x32x16_bf16 v[18:33], v[98:101], v[86:89], 0
    ds_read_b64_tr_b16 v[102:103], v133 offset:19456
    ds_read_b64_tr_b16 v[104:105], v133 offset:20480
    ds_read_b64_tr_b16 v[110:111], v137 offset:19456
    v_exp_f32 v2, v2
    v_exp_f32 v3, v3
    v_exp_f32 v4, v4
    v_exp_f32 v5, v5
    v_cvt_pk_bf16_f32 v34, v2, v3
    v_cvt_pk_bf16_f32 v35, v4, v5
    v_mfma_f32_32x32x16_bf16 v[18:33], v[106:109], v[94:97], v[18:33]
    ds_read_b128 v[114:117], v142 offset:19456
    ds_read_b128 v[118:121], v143 offset:19456
    v_exp_f32 v6, v6
    v_exp_f32 v7, v7
    v_exp_f32 v8, v8
    v_exp_f32 v9, v9
    v_cvt_pk_bf16_f32 v36, v6, v7
    v_cvt_pk_bf16_f32 v37, v8, v9
    v_mfma_f32_32x32x16_bf16 v[66:81], v[122:125], v[42:45], v[66:81]
    v_exp_f32 v10, v10
    v_exp_f32 v11, v11
    v_exp_f32 v12, v12
    v_exp_f32 v13, v13
    v_cvt_pk_bf16_f32 v38, v10, v11
    v_cvt_pk_bf16_f32 v39, v12, v13
    v_mfma_f32_32x32x16_bf16 v[66:81], v[126:129], v[46:49], v[66:81]
    v_exp_f32 v14, v14
    v_exp_f32 v15, v15
    v_exp_f32 v16, v16
    v_exp_f32 v17, v17
    v_cvt_pk_bf16_f32 v40, v14, v15
    v_cvt_pk_bf16_f32 v41, v16, v17
    s_waitcnt lgkmcnt(0)
    v_mfma_f32_32x32x16_bf16 v[2:17], v[102:105], v[82:85], 0
    v_exp_f32 v18, v18
    v_exp_f32 v19, v19
    v_exp_f32 v20, v20
    v_exp_f32 v21, v21
    v_cvt_pk_bf16_f32 v42, v18, v19
    v_cvt_pk_bf16_f32 v43, v20, v21
    v_mfma_f32_32x32x16_bf16 v[2:17], v[110:113], v[90:93], v[2:17]
    v_exp_f32 v22, v22
    v_exp_f32 v23, v23
    v_exp_f32 v24, v24
    v_exp_f32 v25, v25
    v_cvt_pk_bf16_f32 v44, v22, v23
    v_cvt_pk_bf16_f32 v45, v24, v25
    v_mfma_f32_32x32x16_bf16 v[50:65], v[114:117], v[34:37], v[50:65]
    v_exp_f32 v26, v26
    v_exp_f32 v27, v27
    v_exp_f32 v28, v28
    v_exp_f32 v29, v29
    v_cvt_pk_bf16_f32 v46, v26, v27
    v_cvt_pk_bf16_f32 v47, v28, v29
    v_mfma_f32_32x32x16_bf16 v[50:65], v[118:121], v[38:41], v[50:65]
    v_exp_f32 v30, v30
    v_exp_f32 v31, v31
    v_exp_f32 v32, v32
    v_exp_f32 v33, v33
    v_cvt_pk_bf16_f32 v48, v30, v31
    v_cvt_pk_bf16_f32 v49, v32, v33
    v_mfma_f32_32x32x16_bf16 v[18:33], v[102:105], v[86:89], 0
    ds_read_b64_tr_b16 v[98:99], v130 offset:29184
    ds_read_b64_tr_b16 v[100:101], v130 offset:30208
    ds_read_b64_tr_b16 v[106:107], v134 offset:29184
    v_exp_f32 v2, v2
    v_exp_f32 v3, v3
    v_exp_f32 v4, v4
    v_exp_f32 v5, v5
    v_cvt_pk_bf16_f32 v34, v2, v3
    v_cvt_pk_bf16_f32 v35, v4, v5
    v_mfma_f32_32x32x16_bf16 v[18:33], v[110:113], v[94:97], v[18:33]
    ds_read_b128 v[122:125], v144 offset:19456
    ds_read_b128 v[126:129], v145 offset:19456
    v_exp_f32 v6, v6
    v_exp_f32 v7, v7
    v_exp_f32 v8, v8
    v_exp_f32 v9, v9
    v_cvt_pk_bf16_f32 v36, v6, v7
    v_cvt_pk_bf16_f32 v37, v8, v9
    v_mfma_f32_32x32x16_bf16 v[66:81], v[114:117], v[42:45], v[66:81]
    v_exp_f32 v10, v10
    v_exp_f32 v11, v11
    v_exp_f32 v12, v12
    v_exp_f32 v13, v13
    v_cvt_pk_bf16_f32 v38, v10, v11
    v_cvt_pk_bf16_f32 v39, v12, v13
    v_mfma_f32_32x32x16_bf16 v[66:81], v[118:121], v[46:49], v[66:81]
    v_exp_f32 v14, v14
    v_exp_f32 v15, v15
    v_exp_f32 v16, v16
    v_exp_f32 v17, v17
    v_cvt_pk_bf16_f32 v40, v14, v15
    v_cvt_pk_bf16_f32 v41, v16, v17
    s_waitcnt lgkmcnt(0)
    s_barrier
    v_mfma_f32_32x32x16_bf16 v[2:17], v[98:101], v[82:85], 0
    v_exp_f32 v18, v18
    v_exp_f32 v19, v19
    v_exp_f32 v20, v20
    v_exp_f32 v21, v21
    v_cvt_pk_bf16_f32 v42, v18, v19
    v_cvt_pk_bf16_f32 v43, v20, v21
    v_mfma_f32_32x32x16_bf16 v[2:17], v[106:109], v[90:93], v[2:17]
    v_exp_f32 v22, v22
    v_exp_f32 v23, v23
    v_exp_f32 v24, v24
    v_exp_f32 v25, v25
    v_cvt_pk_bf16_f32 v44, v22, v23
    v_cvt_pk_bf16_f32 v45, v24, v25
    v_mfma_f32_32x32x16_bf16 v[50:65], v[122:125], v[34:37], v[50:65]
    v_exp_f32 v26, v26
    v_exp_f32 v27, v27
    v_exp_f32 v28, v28
    v_exp_f32 v29, v29
    v_cvt_pk_bf16_f32 v46, v26, v27
    v_cvt_pk_bf16_f32 v47, v28, v29
    v_mfma_f32_32x32x16_bf16 v[50:65], v[126:129], v[38:41], v[50:65]
    v_exp_f32 v30, v30
    v_exp_f32 v31, v31
    v_exp_f32 v32, v32
    v_exp_f32 v33, v33
    v_cvt_pk_bf16_f32 v48, v30, v31
    v_cvt_pk_bf16_f32 v49, v32, v33
    v_mfma_f32_32x32x16_bf16 v[18:33], v[98:101], v[86:89], 0
    ds_read_b64_tr_b16 v[102:103], v131 offset:29184
    ds_read_b64_tr_b16 v[104:105], v131 offset:30208
    ds_read_b64_tr_b16 v[110:111], v135 offset:29184
    v_exp_f32 v2, v2
    v_exp_f32 v3, v3
    v_exp_f32 v4, v4
    v_exp_f32 v5, v5
    v_cvt_pk_bf16_f32 v34, v2, v3
    v_cvt_pk_bf16_f32 v35, v4, v5
    v_mfma_f32_32x32x16_bf16 v[18:33], v[106:109], v[94:97], v[18:33]
    ds_read_b128 v[114:117], v138 offset:29184
    ds_read_b128 v[118:121], v139 offset:29184
    v_exp_f32 v6, v6
    v_exp_f32 v7, v7
    v_exp_f32 v8, v8
    v_exp_f32 v9, v9
    v_cvt_pk_bf16_f32 v36, v6, v7
    v_cvt_pk_bf16_f32 v37, v8, v9
    v_mfma_f32_32x32x16_bf16 v[66:81], v[122:125], v[42:45], v[66:81]
    v_exp_f32 v10, v10
    v_exp_f32 v11, v11
    v_exp_f32 v12, v12
    v_exp_f32 v13, v13
    v_cvt_pk_bf16_f32 v38, v10, v11
    v_cvt_pk_bf16_f32 v39, v12, v13
    v_mfma_f32_32x32x16_bf16 v[66:81], v[126:129], v[46:49], v[66:81]
    v_exp_f32 v14, v14
    v_exp_f32 v15, v15
    v_exp_f32 v16, v16
    v_exp_f32 v17, v17
    v_cvt_pk_bf16_f32 v40, v14, v15
    v_cvt_pk_bf16_f32 v41, v16, v17
    s_waitcnt lgkmcnt(0)
    v_mfma_f32_32x32x16_bf16 v[2:17], v[102:105], v[82:85], 0
    v_exp_f32 v18, v18
    v_exp_f32 v19, v19
    v_exp_f32 v20, v20
    v_exp_f32 v21, v21
    v_cvt_pk_bf16_f32 v42, v18, v19
    v_cvt_pk_bf16_f32 v43, v20, v21
    v_mfma_f32_32x32x16_bf16 v[2:17], v[110:113], v[90:93], v[2:17]
    v_exp_f32 v22, v22
    v_exp_f32 v23, v23
    v_exp_f32 v24, v24
    v_exp_f32 v25, v25
    v_cvt_pk_bf16_f32 v44, v22, v23
    v_cvt_pk_bf16_f32 v45, v24, v25
    v_mfma_f32_32x32x16_bf16 v[50:65], v[114:117], v[34:37], v[50:65]
    v_exp_f32 v26, v26
    v_exp_f32 v27, v27
    v_exp_f32 v28, v28
    v_exp_f32 v29, v29
    v_cvt_pk_bf16_f32 v46, v26, v27
    v_cvt_pk_bf16_f32 v47, v28, v29
    v_mfma_f32_32x32x16_bf16 v[50:65], v[118:121], v[38:41], v[50:65]
    v_exp_f32 v30, v30
    v_exp_f32 v31, v31
    v_exp_f32 v32, v32
    v_exp_f32 v33, v33
    v_cvt_pk_bf16_f32 v48, v30, v31
    v_cvt_pk_bf16_f32 v49, v32, v33
    v_mfma_f32_32x32x16_bf16 v[18:33], v[102:105], v[86:89], 0
    ds_read_b64_tr_b16 v[98:99], v132 offset:29184
    ds_read_b64_tr_b16 v[100:101], v132 offset:30208
    ds_read_b64_tr_b16 v[106:107], v136 offset:29184
    v_exp_f32 v2, v2
    v_exp_f32 v3, v3
    v_exp_f32 v4, v4
    v_exp_f32 v5, v5
    v_cvt_pk_bf16_f32 v34, v2, v3
    v_cvt_pk_bf16_f32 v35, v4, v5
    v_mfma_f32_32x32x16_bf16 v[18:33], v[110:113], v[94:97], v[18:33]
    ds_read_b128 v[122:125], v140 offset:29184
    ds_read_b128 v[126:129], v141 offset:29184
    v_exp_f32 v6, v6
    v_exp_f32 v7, v7
    v_exp_f32 v8, v8
    v_exp_f32 v9, v9
    v_cvt_pk_bf16_f32 v36, v6, v7
    v_cvt_pk_bf16_f32 v37, v8, v9
    v_mfma_f32_32x32x16_bf16 v[66:81], v[114:117], v[42:45], v[66:81]
    v_exp_f32 v10, v10
    v_exp_f32 v11, v11
    v_exp_f32 v12, v12
    v_exp_f32 v13, v13
    v_cvt_pk_bf16_f32 v38, v10, v11
    v_cvt_pk_bf16_f32 v39, v12, v13
    v_mfma_f32_32x32x16_bf16 v[66:81], v[118:121], v[46:49], v[66:81]
    v_exp_f32 v14, v14
    v_exp_f32 v15, v15
    v_exp_f32 v16, v16
    v_exp_f32 v17, v17
    v_cvt_pk_bf16_f32 v40, v14, v15
    v_cvt_pk_bf16_f32 v41, v16, v17
    s_waitcnt lgkmcnt(0)
    v_mfma_f32_32x32x16_bf16 v[2:17], v[98:101], v[82:85], 0
    v_exp_f32 v18, v18
    v_exp_f32 v19, v19
    v_exp_f32 v20, v20
    v_exp_f32 v21, v21
    v_cvt_pk_bf16_f32 v42, v18, v19
    v_cvt_pk_bf16_f32 v43, v20, v21
    v_mfma_f32_32x32x16_bf16 v[2:17], v[106:109], v[90:93], v[2:17]
    v_exp_f32 v22, v22
    v_exp_f32 v23, v23
    v_exp_f32 v24, v24
    v_exp_f32 v25, v25
    v_cvt_pk_bf16_f32 v44, v22, v23
    v_cvt_pk_bf16_f32 v45, v24, v25
    v_mfma_f32_32x32x16_bf16 v[50:65], v[122:125], v[34:37], v[50:65]
    v_exp_f32 v26, v26
    v_exp_f32 v27, v27
    v_exp_f32 v28, v28
    v_exp_f32 v29, v29
    v_cvt_pk_bf16_f32 v46, v26, v27
    v_cvt_pk_bf16_f32 v47, v28, v29
    v_mfma_f32_32x32x16_bf16 v[50:65], v[126:129], v[38:41], v[50:65]
    v_exp_f32 v30, v30
    v_exp_f32 v31, v31
    v_exp_f32 v32, v32
    v_exp_f32 v33, v33
    v_cvt_pk_bf16_f32 v48, v30, v31
    v_cvt_pk_bf16_f32 v49, v32, v33
    v_mfma_f32_32x32x16_bf16 v[18:33], v[98:101], v[86:89], 0
    ds_read_b64_tr_b16 v[102:103], v133 offset:29184
    ds_read_b64_tr_b16 v[104:105], v133 offset:30208
    ds_read_b64_tr_b16 v[110:111], v137 offset:29184
    v_exp_f32 v2, v2
    v_exp_f32 v3, v3
    v_exp_f32 v4, v4
    v_exp_f32 v5, v5
    v_cvt_pk_bf16_f32 v34, v2, v3
    v_cvt_pk_bf16_f32 v35, v4, v5
    v_mfma_f32_32x32x16_bf16 v[18:33], v[106:109], v[94:97], v[18:33]
    ds_read_b128 v[114:117], v142 offset:29184
    ds_read_b128 v[118:121], v143 offset:29184
    v_exp_f32 v6, v6
    v_exp_f32 v7, v7
    v_exp_f32 v8, v8
    v_exp_f32 v9, v9
    v_cvt_pk_bf16_f32 v36, v6, v7
    v_cvt_pk_bf16_f32 v37, v8, v9
    v_mfma_f32_32x32x16_bf16 v[66:81], v[122:125], v[42:45], v[66:81]
    v_exp_f32 v10, v10
    v_exp_f32 v11, v11
    v_exp_f32 v12, v12
    v_exp_f32 v13, v13
    v_cvt_pk_bf16_f32 v38, v10, v11
    v_cvt_pk_bf16_f32 v39, v12, v13
    v_mfma_f32_32x32x16_bf16 v[66:81], v[126:129], v[46:49], v[66:81]
    v_exp_f32 v14, v14
    v_exp_f32 v15, v15
    v_exp_f32 v16, v16
    v_exp_f32 v17, v17
    v_cvt_pk_bf16_f32 v40, v14, v15
    v_cvt_pk_bf16_f32 v41, v16, v17
    s_waitcnt lgkmcnt(0)
    v_mfma_f32_32x32x16_bf16 v[2:17], v[102:105], v[82:85], 0
    v_exp_f32 v18, v18
    v_exp_f32 v19, v19
    v_exp_f32 v20, v20
    v_exp_f32 v21, v21
    v_cvt_pk_bf16_f32 v42, v18, v19
    v_cvt_pk_bf16_f32 v43, v20, v21
    v_mfma_f32_32x32x16_bf16 v[2:17], v[110:113], v[90:93], v[2:17]
    v_exp_f32 v22, v22
    v_exp_f32 v23, v23
    v_exp_f32 v24, v24
    v_exp_f32 v25, v25
    v_cvt_pk_bf16_f32 v44, v22, v23
    v_cvt_pk_bf16_f32 v45, v24, v25
    v_mfma_f32_32x32x16_bf16 v[50:65], v[114:117], v[34:37], v[50:65]
    v_exp_f32 v26, v26
    v_exp_f32 v27, v27
    v_exp_f32 v28, v28
    v_exp_f32 v29, v29
    v_cvt_pk_bf16_f32 v46, v26, v27
    v_cvt_pk_bf16_f32 v47, v28, v29
    v_mfma_f32_32x32x16_bf16 v[50:65], v[118:121], v[38:41], v[50:65]
    v_exp_f32 v30, v30
    v_exp_f32 v31, v31
    v_exp_f32 v32, v32
    v_exp_f32 v33, v33
    v_cvt_pk_bf16_f32 v48, v30, v31
    v_cvt_pk_bf16_f32 v49, v32, v33
    v_mfma_f32_32x32x16_bf16 v[18:33], v[102:105], v[86:89], 0
    ds_read_b64_tr_b16 v[98:99], v130 offset:0
    ds_read_b64_tr_b16 v[100:101], v130 offset:1024
    ds_read_b64_tr_b16 v[106:107], v134 offset:0
    v_exp_f32 v2, v2
    v_exp_f32 v3, v3
    v_exp_f32 v4, v4
    v_exp_f32 v5, v5
    v_cvt_pk_bf16_f32 v34, v2, v3
    v_cvt_pk_bf16_f32 v35, v4, v5
    v_mfma_f32_32x32x16_bf16 v[18:33], v[110:113], v[94:97], v[18:33]
    ds_read_b128 v[122:125], v144 offset:29184
    ds_read_b128 v[126:129], v145 offset:29184
    v_exp_f32 v6, v6
    v_exp_f32 v7, v7
    v_exp_f32 v8, v8
    v_exp_f32 v9, v9
    v_cvt_pk_bf16_f32 v36, v6, v7
    v_cvt_pk_bf16_f32 v37, v8, v9
    v_mfma_f32_32x32x16_bf16 v[66:81], v[114:117], v[42:45], v[66:81]
    v_exp_f32 v10, v10
    v_exp_f32 v11, v11
    v_exp_f32 v12, v12
    v_exp_f32 v13, v13
    v_cvt_pk_bf16_f32 v38, v10, v11
    v_cvt_pk_bf16_f32 v39, v12, v13
    v_mfma_f32_32x32x16_bf16 v[66:81], v[118:121], v[46:49], v[66:81]
    v_exp_f32 v14, v14
    v_exp_f32 v15, v15
    v_exp_f32 v16, v16
    v_exp_f32 v17, v17
    v_cvt_pk_bf16_f32 v40, v14, v15
    v_cvt_pk_bf16_f32 v41, v16, v17
    s_waitcnt lgkmcnt(0)
    s_barrier
    v_mfma_f32_32x32x16_bf16 v[2:17], v[98:101], v[82:85], 0
    v_exp_f32 v18, v18
    v_exp_f32 v19, v19
    v_exp_f32 v20, v20
    v_exp_f32 v21, v21
    v_cvt_pk_bf16_f32 v42, v18, v19
    v_cvt_pk_bf16_f32 v43, v20, v21
    v_mfma_f32_32x32x16_bf16 v[2:17], v[106:109], v[90:93], v[2:17]
    v_exp_f32 v22, v22
    v_exp_f32 v23, v23
    v_exp_f32 v24, v24
    v_exp_f32 v25, v25
    v_cvt_pk_bf16_f32 v44, v22, v23
    v_cvt_pk_bf16_f32 v45, v24, v25
    v_mfma_f32_32x32x16_bf16 v[50:65], v[122:125], v[34:37], v[50:65]
    v_exp_f32 v26, v26
    v_exp_f32 v27, v27
    v_exp_f32 v28, v28
    v_exp_f32 v29, v29
    v_cvt_pk_bf16_f32 v46, v26, v27
    v_cvt_pk_bf16_f32 v47, v28, v29
    v_mfma_f32_32x32x16_bf16 v[50:65], v[126:129], v[38:41], v[50:65]
    v_exp_f32 v30, v30
    v_exp_f32 v31, v31
    v_exp_f32 v32, v32
    v_exp_f32 v33, v33
    v_cvt_pk_bf16_f32 v48, v30, v31
    v_cvt_pk_bf16_f32 v49, v32, v33
    s_add_u32 s32, s32, 1
    s_cmp_lt_u32 s32, 4
    s_cbranch_scc1 K2_ALOOP
    s_nop 1
    v_mfma_f32_32x32x16_bf16 v[66:81], v[122:125], v[42:45], v[66:81]
    v_mfma_f32_32x32x16_bf16 v[66:81], v[126:129], v[46:49], v[66:81]
    s_nop 7
    s_nop 7
    s_mov_b32 s11, 0x76800000
    s_mov_b32 s12, 0xd800000
    v_cmp_nlt_f32 vcc, v60, s11
    v_cmp_nlt_f32 s[48:49], v76, s11
    s_nop 3
    s_or_b64 s[48:49], vcc, s[48:49]
    v_cmp_ngt_f32 vcc, v60, s12
    s_nop 3
    s_or_b64 s[48:49], vcc, s[48:49]
    v_cmp_ngt_f32 vcc, v76, s12
    s_nop 3
    s_or_b64 vcc, vcc, s[48:49]
    s_and_b32 s11, vcc_lo, -1
    s_cbranch_scc1 K2_FALLBACK
K2_AEPI:
    s_add_u32 s16, s6, 37804032
    s_addc_u32 s17, s7, 0
    s_mov_b32 s18, 2359296
    s_mov_b32 s19, 0x00020000
    s_lshr_b32 s11, s9, 3
    s_add_u32 s11, s11, 32
    s_lshl_b32 s11, s11, 10
    s_and_b32 s12, s9, 4
    s_lshl_b32 s12, s12, 7
    s_add_u32 s11, s11, s12
    s_and_b32 s12, s9, 3
    s_lshl_b32 s12, s12, 2
    s_add_u32 s11, s11, s12
    s_lshl_b32 s12, s9, 10
    v_mul_f32 v148, 0x3fb8aa3b, v60
    v_mov_b32 v149, v148
    s_nop 1
    v_permlane32_swap_b32 v148, v149
    s_nop 1
    v_rcp_f32 v148, v148
    s_nop 0
    v_mul_f32 v50, v50, v148
    v_mul_f32 v51, v51, v148
    v_mul_f32 v52, v52, v148
    v_mul_f32 v53, v53, v148
    v_mul_f32 v54, v54, v148
    v_mul_f32 v55, v55, v148
    v_mul_f32 v56, v56, v148
    v_mul_f32 v57, v57, v148
    v_mul_f32 v58, v58, v148
    v_mul_f32 v59, v59, v148
    v_cvt_pk_bf16_f32 v150, v50, v51
    v_cvt_pk_bf16_f32 v151, v52, v53
    v_cvt_pk_bf16_f32 v152, v54, v55
    v_cvt_pk_bf16_f32 v153, v56, v57
    v_cvt_pk_bf16_f32 v154, v58, v59
    v_lshrrev_b32 v162, 5, v166
    v_mul_u32_u24 v162, 36864, v162
    v_permlane32_swap_b32 v150, v152
    v_permlane32_swap_b32 v151, v153
    v_lshl_add_u32 v149, v0, 4, v162
    v_and_b32 v148, 31, v0
    v_lshl_add_u32 v148, v148, 4, v162
    buffer_store_dwordx4 v[150:153], v149, s[16:19], s12 offen sc1
    v_cmp_gt_u32 vcc, 32, v0
    s_nop 1
    s_and_saveexec_b64 s[48:49], vcc
    buffer_store_dword v154, v148, s[16:19], s11 offen
    s_mov_b64 exec, s[48:49]
    v_mul_f32 v148, 0x3fb8aa3b, v76
    v_mov_b32 v149, v148
    s_nop 1
    v_permlane32_swap_b32 v148, v149
    s_nop 1
    v_rcp_f32 v148, v148
    s_nop 0
    v_mul_f32 v66, v66, v148
    v_mul_f32 v67, v67, v148
    v_mul_f32 v68, v68, v148
    v_mul_f32 v69, v69, v148
    v_mul_f32 v70, v70, v148
    v_mul_f32 v71, v71, v148
    v_mul_f32 v72, v72, v148
    v_mul_f32 v73, v73, v148
    v_mul_f32 v74, v74, v148
    v_mul_f32 v75, v75, v148
    v_cvt_pk_bf16_f32 v156, v66, v67
    v_cvt_pk_bf16_f32 v157, v68, v69
    v_cvt_pk_bf16_f32 v158, v70, v71
    v_cvt_pk_bf16_f32 v159, v72, v73
    v_cvt_pk_bf16_f32 v160, v74, v75
    v_lshrrev_b32 v163, 5, v167
    v_mul_u32_u24 v163, 36864, v163
    v_permlane32_swap_b32 v156, v158
    v_permlane32_swap_b32 v157, v159
    v_lshl_add_u32 v149, v0, 4, v163
    v_and_b32 v148, 31, v0
    v_lshl_add_u32 v148, v148, 4, v163
    buffer_store_dwordx4 v[156:159], v149, s[16:19], s12 offen sc1
    v_cmp_gt_u32 vcc, 32, v0
    s_nop 1
    s_and_saveexec_b64 s[48:49], vcc
    buffer_store_dword v160, v148, s[16:19], s11 offen
    s_mov_b64 exec, s[48:49]
    s_endpgm
K2_FALLBACK:
    s_mov_b32 s16, s6
    s_mov_b32 s17, s7
    s_mov_b32 s18, 7133184
    s_mov_b32 s19, 0x00020000
    v_and_b32 v146, 31, v0
    v_lshrrev_b32 v147, 5, v0
    v_and_b32 v150, 0xfffffff3, v146
    v_and_b32 v148, 4, v146
    v_lshl_add_u32 v150, v148, 1, v150
    v_and_b32 v148, 8, v146
    v_lshrrev_b32 v148, 1, v148
    v_add_u32 v150, v150, v148
    v_lshrrev_b32 v161, 5, v150
    v_lshlrev_b32 v161, 8, v161
    v_and_b32 v148, 16, v150
    v_lshl_add_u32 v161, v148, 3, v161
    v_and_b32 v148, 15, v150
    v_lshl_add_u32 v161, v148, 1, v161
    s_mul_i32 s36, s9, 18
    s_add_u32 s37, s36, 1152
    s_add_u32 s36, s36, 576
    v_min_u32 v149, 17, v146
    v_add_u32 v149, s37, v149
    v_lshrrev_b32 v159, 2, v149
    v_mul_u32_u24 v159, 16512, v159
    v_and_b32 v149, 3, v149
    v_lshl_add_u32 v159, v149, 5, v159
    v_lshl_add_u32 v159, v147, 4, v159
    v_mov_b32 v91, 0
    v_mov_b32 v154, 0xff800000
    v_mov_b32 v95, 0
    v_mov_b32 v155, 0xff800000
    v_mov_b32 v107, 0x3f803f80
    s_mov_b32 s32, 0
    v_mov_b32 v158, v161
K2_FB1:
    v_mul_u32_u24 v162, 33024, v147
    v_add_u32 v162, v162, v158
    s_add_u32 s13, s36, 0
    s_and_b32 s11, s13, 3
    s_lshr_b32 s13, s13, 2
    s_mul_i32 s13, s13, 16512
    s_lshl_b32 s11, s11, 5
    s_add_u32 s13, s13, s11
    buffer_load_ushort v2, v162, s[16:19], s13 offen
    s_add_u32 s13, s36, 1
    s_and_b32 s11, s13, 3
    s_lshr_b32 s13, s13, 2
    s_mul_i32 s13, s13, 16512
    s_lshl_b32 s11, s11, 5
    s_add_u32 s13, s13, s11
    buffer_load_ushort v3, v162, s[16:19], s13 offen
    s_add_u32 s13, s36, 2
    s_and_b32 s11, s13, 3
    s_lshr_b32 s13, s13, 2
    s_mul_i32 s13, s13, 16512
    s_lshl_b32 s11, s11, 5
    s_add_u32 s13, s13, s11
    buffer_load_ushort v4, v162, s[16:19], s13 offen
    s_add_u32 s13, s36, 3
    s_and_b32 s11, s13, 3
    s_lshr_b32 s13, s13, 2
    s_mul_i32 s13, s13, 16512
    s_lshl_b32 s11, s11, 5
    s_add_u32 s13, s13, s11
    buffer_load_ushort v5, v162, s[16:19], s13 offen
    s_add_u32 s13, s36, 4
    s_and_b32 s11, s13, 3
    s_lshr_b32 s13, s13, 2
    s_mul_i32 s13, s13, 16512
    s_lshl_b32 s11, s11, 5
    s_add_u32 s13, s13, s11
    buffer_load_ushort v6, v162, s[16:19], s13 offen
    s_add_u32 s13, s36, 5
    s_and_b32 s11, s13, 3
    s_lshr_b32 s13, s13, 2
    s_mul_i32 s13, s13, 16512
    s_lshl_b32 s11, s11, 5
    s_add_u32 s13, s13, s11
    buffer_load_ushort v7, v162, s[16:19], s13 offen
    s_add_u32 s13, s36, 6
    s_and_b32 s11, s13, 3
    s_lshr_b32 s13, s13, 2
    s_mul_i32 s13, s13, 16512
    s_lshl_b32 s11, s11, 5
    s_add_u32 s13, s13, s11
    buffer_load_ushort v8, v162, s[16:19], s13 offen
    s_add_u32 s13, s36, 7
    s_and_b32 s11, s13, 3
    s_lshr_b32 s13, s13, 2
    s_mul_i32 s13, s13, 16512
    s_lshl_b32 s11, s11, 5
    s_add_u32 s13, s13, s11
    buffer_load_ushort v9, v162, s[16:19], s13 offen
    s_add_u32 s13, s36, 16
    s_and_b32 s11, s13, 3
    s_lshr_b32 s13, s13, 2
    s_mul_i32 s13, s13, 16512
    s_lshl_b32 s11, s11, 5
    s_add_u32 s13, s13, s11
    buffer_load_ushort v10, v158, s[16:19], s13 offen
    s_add_u32 s13, s36, 17
    s_and_b32 s11, s13, 3
    s_lshr_b32 s13, s13, 2
    s_mul_i32 s13, s13, 16512
    s_lshl_b32 s11, s11, 5
    s_add_u32 s13, s13, s11
    buffer_load_ushort v11, v158, s[16:19], s13 offen
    s_waitcnt vmcnt(0)
    v_lshl_or_b32 v98, v3, 16, v2
    v_lshl_or_b32 v99, v5, 16, v4
    v_lshl_or_b32 v100, v7, 16, v6
    v_lshl_or_b32 v101, v9, 16, v8
    v_lshl_or_b32 v106, v11, 16, v10
    s_nop 1
    v_mfma_f32_32x32x16_bf16 v[2:17], v[98:101], v[82:85], 0
    v_mfma_f32_32x32x16_bf16 v[2:17], v[106:109], v[90:93], v[2:17]
    v_mfma_f32_32x32x16_bf16 v[18:33], v[98:101], v[86:89], 0
    v_mfma_f32_32x32x16_bf16 v[18:33], v[106:109], v[94:97], v[18:33]
    s_nop 7
    s_nop 7
    v_max3_f32 v154, v154, v2, v3
    v_max3_f32 v154, v154, v4, v5
    v_max3_f32 v154, v154, v6, v7
    v_max3_f32 v154, v154, v8, v9
    v_max3_f32 v154, v154, v10, v11
    v_max3_f32 v154, v154, v12, v13
    v_max3_f32 v154, v154, v14, v15
    v_max3_f32 v154, v154, v16, v17
    v_max3_f32 v155, v155, v18, v19
    v_max3_f32 v155, v155, v20, v21
    v_max3_f32 v155, v155, v22, v23
    v_max3_f32 v155, v155, v24, v25
    v_max3_f32 v155, v155, v26, v27
    v_max3_f32 v155, v155, v28, v29
    v_max3_f32 v155, v155, v30, v31
    v_max3_f32 v155, v155, v32, v33
    v_add_u32 v158, 256, v158
    s_add_u32 s32, s32, 1
    s_cmp_lt_u32 s32, 64
    s_cbranch_scc1 K2_FB1
    v_mov_b32 v156, v154
    s_nop 1
    v_permlane32_swap_b32 v154, v156
    s_nop 1
    v_max_f32 v156, v154, v156
    v_sub_f32 v156, 0, v156
    v_cvt_pk_bf16_f32 v157, v156, v156
    v_lshlrev_b32 v158, 16, v157
    v_sub_f32 v158, v156, v158
    v_cvt_pk_bf16_f32 v156, v156, v158
    v_cmp_gt_u32 vcc, 32, v0
    v_mov_b32 v157, 0
    s_nop 0
    v_cndmask_b32 v91, v157, v156, vcc
    v_mov_b32 v156, v155
    s_nop 1
    v_permlane32_swap_b32 v155, v156
    s_nop 1
    v_max_f32 v156, v155, v156
    v_sub_f32 v156, 0, v156
    v_cvt_pk_bf16_f32 v157, v156, v156
    v_lshlrev_b32 v158, 16, v157
    v_sub_f32 v158, v156, v158
    v_cvt_pk_bf16_f32 v156, v156, v158
    v_cmp_gt_u32 vcc, 32, v0
    v_mov_b32 v157, 0
    s_nop 0
    v_cndmask_b32 v95, v157, v156, vcc
    s_nop 1
    v_mov_b32 v50, 0
    v_mov_b32 v51, 0
    v_mov_b32 v52, 0
    v_mov_b32 v53, 0
    v_mov_b32 v54, 0
    v_mov_b32 v55, 0
    v_mov_b32 v56, 0
    v_mov_b32 v57, 0
    v_mov_b32 v58, 0
    v_mov_b32 v59, 0
    v_mov_b32 v60, 0
    v_mov_b32 v61, 0
    v_mov_b32 v62, 0
    v_mov_b32 v63, 0
    v_mov_b32 v64, 0
    v_mov_b32 v65, 0
    v_mov_b32 v66, 0
    v_mov_b32 v67, 0
    v_mov_b32 v68, 0
    v_mov_b32 v69, 0
    v_mov_b32 v70, 0
    v_mov_b32 v71, 0
    v_mov_b32 v72, 0
    v_mov_b32 v73, 0
    v_mov_b32 v74, 0
    v_mov_b32 v75, 0
    v_mov_b32 v76, 0
    v_mov_b32 v77, 0
    v_mov_b32 v78, 0
    v_mov_b32 v79, 0
    v_mov_b32 v80, 0
    v_mov_b32 v81, 0
    s_mov_b32 s32, 0
    v_mov_b32 v158, v161
    s_mov_b32 s37, 0
    v_mov_b32 v160, 0x3f803f80
K2_FB2:
    v_mul_u32_u24 v162, 33024, v147
    v_add_u32 v162, v162, v158
    s_add_u32 s13, s36, 0
    s_and_b32 s11, s13, 3
    s_lshr_b32 s13, s13, 2
    s_mul_i32 s13, s13, 16512
    s_lshl_b32 s11, s11, 5
    s_add_u32 s13, s13, s11
    buffer_load_ushort v2, v162, s[16:19], s13 offen
    s_add_u32 s13, s36, 1
    s_and_b32 s11, s13, 3
    s_lshr_b32 s13, s13, 2
    s_mul_i32 s13, s13, 16512
    s_lshl_b32 s11, s11, 5
    s_add_u32 s13, s13, s11
    buffer_load_ushort v3, v162, s[16:19], s13 offen
    s_add_u32 s13, s36, 2
    s_and_b32 s11, s13, 3
    s_lshr_b32 s13, s13, 2
    s_mul_i32 s13, s13, 16512
    s_lshl_b32 s11, s11, 5
    s_add_u32 s13, s13, s11
    buffer_load_ushort v4, v162, s[16:19], s13 offen
    s_add_u32 s13, s36, 3
    s_and_b32 s11, s13, 3
    s_lshr_b32 s13, s13, 2
    s_mul_i32 s13, s13, 16512
    s_lshl_b32 s11, s11, 5
    s_add_u32 s13, s13, s11
    buffer_load_ushort v5, v162, s[16:19], s13 offen
    s_add_u32 s13, s36, 4
    s_and_b32 s11, s13, 3
    s_lshr_b32 s13, s13, 2
    s_mul_i32 s13, s13, 16512
    s_lshl_b32 s11, s11, 5
    s_add_u32 s13, s13, s11
    buffer_load_ushort v6, v162, s[16:19], s13 offen
    s_add_u32 s13, s36, 5
    s_and_b32 s11, s13, 3
    s_lshr_b32 s13, s13, 2
    s_mul_i32 s13, s13, 16512
    s_lshl_b32 s11, s11, 5
    s_add_u32 s13, s13, s11
    buffer_load_ushort v7, v162, s[16:19], s13 offen
    s_add_u32 s13, s36, 6
    s_and_b32 s11, s13, 3
    s_lshr_b32 s13, s13, 2
    s_mul_i32 s13, s13, 16512
    s_lshl_b32 s11, s11, 5
    s_add_u32 s13, s13, s11
    buffer_load_ushort v8, v162, s[16:19], s13 offen
    s_add_u32 s13, s36, 7
    s_and_b32 s11, s13, 3
    s_lshr_b32 s13, s13, 2
    s_mul_i32 s13, s13, 16512
    s_lshl_b32 s11, s11, 5
    s_add_u32 s13, s13, s11
    buffer_load_ushort v9, v162, s[16:19], s13 offen
    s_add_u32 s13, s36, 16
    s_and_b32 s11, s13, 3
    s_lshr_b32 s13, s13, 2
    s_mul_i32 s13, s13, 16512
    s_lshl_b32 s11, s11, 5
    s_add_u32 s13, s13, s11
    buffer_load_ushort v10, v158, s[16:19], s13 offen
    s_add_u32 s13, s36, 17
    s_and_b32 s11, s13, 3
    s_lshr_b32 s13, s13, 2
    s_mul_i32 s13, s13, 16512
    s_lshl_b32 s11, s11, 5
    s_add_u32 s13, s13, s11
    buffer_load_ushort v11, v158, s[16:19], s13 offen
    buffer_load_dwordx4 v[114:117], v159, s[16:19], s37 offen offset:0
    buffer_load_dwordx4 v[118:121], v159, s[16:19], s37 offen offset:128
    s_waitcnt vmcnt(0)
    v_lshl_or_b32 v98, v3, 16, v2
    v_lshl_or_b32 v99, v5, 16, v4
    v_lshl_or_b32 v100, v7, 16, v6
    v_lshl_or_b32 v101, v9, 16, v8
    v_lshl_or_b32 v106, v11, 16, v10
    v_cmp_eq_u32 vcc, 18, v146
    s_nop 1
    v_cndmask_b32 v114, v114, v160, vcc
    v_cndmask_b32 v115, v115, v160, vcc
    v_cndmask_b32 v116, v116, v160, vcc
    v_cndmask_b32 v117, v117, v160, vcc
    v_cndmask_b32 v118, v118, v160, vcc
    v_cndmask_b32 v119, v119, v160, vcc
    v_cndmask_b32 v120, v120, v160, vcc
    v_cndmask_b32 v121, v121, v160, vcc
    v_mfma_f32_32x32x16_bf16 v[2:17], v[98:101], v[82:85], 0
    v_mfma_f32_32x32x16_bf16 v[2:17], v[106:109], v[90:93], v[2:17]
    v_mfma_f32_32x32x16_bf16 v[18:33], v[98:101], v[86:89], 0
    v_mfma_f32_32x32x16_bf16 v[18:33], v[106:109], v[94:97], v[18:33]
    s_nop 7
    s_nop 7
    v_exp_f32 v2, v2
    v_exp_f32 v3, v3
    v_exp_f32 v4, v4
    v_exp_f32 v5, v5
    v_cvt_pk_bf16_f32 v34, v2, v3
    v_cvt_pk_bf16_f32 v35, v4, v5
    v_exp_f32 v6, v6
    v_exp_f32 v7, v7
    v_exp_f32 v8, v8
    v_exp_f32 v9, v9
    v_cvt_pk_bf16_f32 v36, v6, v7
    v_cvt_pk_bf16_f32 v37, v8, v9
    v_exp_f32 v10, v10
    v_exp_f32 v11, v11
    v_exp_f32 v12, v12
    v_exp_f32 v13, v13
    v_cvt_pk_bf16_f32 v38, v10, v11
    v_cvt_pk_bf16_f32 v39, v12, v13
    v_exp_f32 v14, v14
    v_exp_f32 v15, v15
    v_exp_f32 v16, v16
    v_exp_f32 v17, v17
    v_cvt_pk_bf16_f32 v40, v14, v15
    v_cvt_pk_bf16_f32 v41, v16, v17
    v_exp_f32 v18, v18
    v_exp_f32 v19, v19
    v_exp_f32 v20, v20
    v_exp_f32 v21, v21
    v_cvt_pk_bf16_f32 v42, v18, v19
    v_cvt_pk_bf16_f32 v43, v20, v21
    v_exp_f32 v22, v22
    v_exp_f32 v23, v23
    v_exp_f32 v24, v24
    v_exp_f32 v25, v25
    v_cvt_pk_bf16_f32 v44, v22, v23
    v_cvt_pk_bf16_f32 v45, v24, v25
    v_exp_f32 v26, v26
    v_exp_f32 v27, v27
    v_exp_f32 v28, v28
    v_exp_f32 v29, v29
    v_cvt_pk_bf16_f32 v46, v26, v27
    v_cvt_pk_bf16_f32 v47, v28, v29
    v_exp_f32 v30, v30
    v_exp_f32 v31, v31
    v_exp_f32 v32, v32
    v_exp_f32 v33, v33
    v_cvt_pk_bf16_f32 v48, v30, v31
    v_cvt_pk_bf16_f32 v49, v32, v33
    s_nop 1
    v_mfma_f32_32x32x16_bf16 v[50:65], v[114:117], v[34:37], v[50:65]
    v_mfma_f32_32x32x16_bf16 v[50:65], v[118:121], v[38:41], v[50:65]
    v_mfma_f32_32x32x16_bf16 v[66:81], v[114:117], v[42:45], v[66:81]
    v_mfma_f32_32x32x16_bf16 v[66:81], v[118:121], v[46:49], v[66:81]
    v_add_u32 v158, 256, v158
    s_add_u32 s37, s37, 256
    s_add_u32 s32, s32, 1
    s_cmp_lt_u32 s32, 64
    s_cbranch_scc1 K2_FB2
    s_nop 7
    s_nop 7
    s_branch K2_AEPI
K2_PROD:
    s_sub_u32 s41, s8, 4
    s_and_b32 s11, s2, 7
    s_mul_i32 s11, s11, 30
    s_lshr_b32 s12, s2, 3
    s_add_u32 s11, s11, s12
    s_mul_hi_u32 s42, s11, 89478486
    s_mul_i32 s13, s42, 48
    s_sub_u32 s13, s11, s13
    s_mul_hi_u32 s43, s13, 1431655766
    s_mul_i32 s44, s43, 3
    s_sub_u32 s44, s13, s44
    s_cmp_lt_u32 s42, 2
    s_cselect_b32 s33, 15, 14
    s_mul_i32 s45, s42, 15
    s_max_u32 s13, s42, 2
    s_sub_u32 s13, s13, 2
    s_sub_u32 s45, s45, s13
    s_cmp_lt_u32 s12, 30
    s_cselect_b32 s33, s33, 0
    s_mov_b32 s16, s6
    s_mov_b32 s17, s7
    s_mov_b32 s18, 7133184
    s_mov_b32 s19, 0x00020000
    s_add_u32 s24, s6, 7133184
    s_addc_u32 s25, s7, 0
    s_mov_b32 s26, 18874368
    s_mov_b32 s27, 0x00020000
    s_mov_b32 s28, s4
    s_mov_b32 s29, s5
    s_mov_b32 s30, 5308416
    s_mov_b32 s31, 0x00020000
    v_and_b32 v154, 31, v0
    v_lshrrev_b32 v155, 5, v0
    s_mul_i32 s50, s9, 18
    s_add_u32 s50, s50, 576
    s_lshl_b32 s11, s41, 2
    v_lshrrev_b32 v156, 4, v0
    v_add_u32 v156, s11, v156
    v_add_u32 v157, -18, v156
    v_and_b32 v158, 15, v157
    v_add_u32 v157, 576, v157
    v_and_b32 v159, 3, v156
    v_lshlrev_b32 v159, 2, v159
    v_cmp_gt_u32 vcc, 18, v156
    s_nop 1
    v_cndmask_b32 v157, v157, v156, vcc
    v_cndmask_b32 v158, v158, v159, vcc
    v_add_u32 v157, s50, v157
    v_and_b32 v159, 15, v0
    v_xor_b32 v158, v158, v159
    v_lshrrev_b32 v159, 2, v157
    v_mul_u32_u24 v150, 16512, v159
    v_and_b32 v159, 3, v157
    v_lshl_add_u32 v150, v159, 5, v150
    v_lshrrev_b32 v159, 1, v158
    v_lshl_add_u32 v150, v159, 7, v150
    v_and_b32 v159, 1, v158
    v_lshl_add_u32 v150, v159, 4, v150
    s_add_u32 s12, s41, 4
    s_lshl_b32 s11, s12, 2
    v_lshrrev_b32 v156, 4, v0
    v_add_u32 v156, s11, v156
    v_add_u32 v157, -18, v156
    v_and_b32 v158, 15, v157
    v_add_u32 v157, 576, v157
    v_and_b32 v159, 3, v156
    v_lshlrev_b32 v159, 2, v159
    v_cmp_gt_u32 vcc, 18, v156
    s_nop 1
    v_cndmask_b32 v157, v157, v156, vcc
    v_cndmask_b32 v158, v158, v159, vcc
    v_add_u32 v157, s50, v157
    v_and_b32 v159, 15, v0
    v_xor_b32 v158, v158, v159
    v_lshrrev_b32 v159, 2, v157
    v_mul_u32_u24 v151, 16512, v159
    v_and_b32 v159, 3, v157
    v_lshl_add_u32 v151, v159, 5, v151
    v_lshrrev_b32 v159, 1, v158
    v_lshl_add_u32 v151, v159, 7, v151
    v_and_b32 v159, 1, v158
    v_lshl_add_u32 v151, v159, 4, v151
    s_add_u32 s12, s41, 4
    s_cmp_eq_u32 s41, 0
    s_cselect_b32 s12, 8, s12
    s_lshl_b32 s11, s12, 2
    v_lshrrev_b32 v156, 4, v0
    v_add_u32 v156, s11, v156
    v_add_u32 v157, -18, v156
    v_and_b32 v158, 15, v157
    v_add_u32 v157, 576, v157
    v_and_b32 v159, 3, v156
    v_lshlrev_b32 v159, 2, v159
    v_cmp_gt_u32 vcc, 18, v156
    s_nop 1
    v_cndmask_b32 v157, v157, v156, vcc
    v_cndmask_b32 v158, v158, v159, vcc
    v_add_u32 v157, s50, v157
    v_and_b32 v159, 15, v0
    v_xor_b32 v158, v158, v159
    v_lshrrev_b32 v159, 2, v157
    v_mul_u32_u24 v152, 16512, v159
    v_and_b32 v159, 3, v157
    v_lshl_add_u32 v152, v159, 5, v152
    v_lshrrev_b32 v159, 1, v158
    v_lshl_add_u32 v152, v159, 7, v152
    v_and_b32 v159, 1, v158
    v_lshl_add_u32 v152, v159, 4, v152
    s_mov_b32 s36, 0
    s_mov_b32 s40, 0
    s_lshl_b32 s11, s41, 10
    s_add_u32 s11, s11, s40
    s_add_u32 m0, s11, 512
    s_cmp_eq_u32 s41, 0
    buffer_load_dwordx4 v150, s[16:19], s36 offen lds
    s_mov_b32 s12, 4096
    s_cselect_b32 s12, 8192, s12
    s_add_u32 m0, m0, 4096
    s_add_u32 s12, s12, s11
    buffer_load_dwordx4 v151, s[16:19], s36 offen lds
    s_add_u32 m0, s12, 512
    s_add_u32 s40, s40, 9728
    buffer_load_dwordx4 v152, s[16:19], s36 offen lds
    s_add_u32 s36, s36, 1024
    s_cmp_ge_u32 s40, 38912
    s_cselect_b32 s40, 0, s40
    s_lshl_b32 s11, s41, 10
    s_add_u32 s11, s11, s40
    s_add_u32 m0, s11, 512
    s_cmp_eq_u32 s41, 0
    buffer_load_dwordx4 v150, s[16:19], s36 offen lds
    s_mov_b32 s12, 4096
    s_cselect_b32 s12, 8192, s12
    s_add_u32 m0, m0, 4096
    s_add_u32 s12, s12, s11
    buffer_load_dwordx4 v151, s[16:19], s36 offen lds
    s_add_u32 m0, s12, 512
    s_add_u32 s40, s40, 9728
    buffer_load_dwordx4 v152, s[16:19], s36 offen lds
    s_add_u32 s36, s36, 1024
    s_cmp_ge_u32 s40, 38912
    s_cselect_b32 s40, 0, s40
    s_lshl_b32 s11, s41, 10
    s_add_u32 s11, s11, s40
    s_add_u32 m0, s11, 512
    s_cmp_eq_u32 s41, 0
    buffer_load_dwordx4 v150, s[16:19], s36 offen lds
    s_mov_b32 s12, 4096
    s_cselect_b32 s12, 8192, s12
    s_add_u32 m0, m0, 4096
    s_add_u32 s12, s12, s11
    buffer_load_dwordx4 v151, s[16:19], s36 offen lds
    s_add_u32 m0, s12, 512
    s_add_u32 s40, s40, 9728
    buffer_load_dwordx4 v152, s[16:19], s36 offen lds
    s_add_u32 s36, s36, 1024
    s_cmp_ge_u32 s40, 38912
    s_cselect_b32 s40, 0, s40
    v_lshlrev_b32 v145, 4, v0
    v_add_u32 v156, 0, v0
    v_mul_u32_u24 v157, 2731, v156
    v_lshrrev_b32 v157, 16, v157
    v_mul_u32_u24 v158, 24, v157
    v_sub_u32 v158, v156, v158
    v_lshrrev_b32 v159, 1, v157
    v_and_b32 v159, 1, v159
    v_lshlrev_b32 v159, 2, v159
    v_xor_b32 v158, v158, v159
    v_lshlrev_b32 v158, 4, v158
    v_mul_u32_u24 v157, 1152, v157
    v_add_u32 v147, v157, v158
    v_add_u32 v156, 64, v0
    v_mul_u32_u24 v157, 2731, v156
    v_lshrrev_b32 v157, 16, v157
    v_mul_u32_u24 v158, 24, v157
    v_sub_u32 v158, v156, v158
    v_lshrrev_b32 v159, 1, v157
    v_and_b32 v159, 1, v159
    v_lshlrev_b32 v159, 2, v159
    v_xor_b32 v158, v158, v159
    v_lshlrev_b32 v158, 4, v158
    v_mul_u32_u24 v157, 1152, v157
    v_add_u32 v148, v157, v158
    v_add_u32 v156, 128, v0
    v_mul_u32_u24 v157, 2731, v156
    v_lshrrev_b32 v157, 16, v157
    v_mul_u32_u24 v158, 24, v157
    v_sub_u32 v158, v156, v158
    v_lshrrev_b32 v159, 1, v157
    v_and_b32 v159, 1, v159
    v_lshlrev_b32 v159, 2, v159
    v_xor_b32 v158, v158, v159
    v_lshlrev_b32 v158, 4, v158
    v_mul_u32_u24 v157, 1152, v157
    v_add_u32 v149, v157, v158
    s_lshl_b32 s11, s43, 2
    s_add_u32 s11, s11, s41
    s_mul_i32 s38, s11, 294912
    s_lshl_b32 s12, s45, 12
    s_add_u32 s38, s38, s12
    s_lshl_b32 s11, s45, 6
    s_lshl_b32 s12, s41, 4
    s_add_u32 s11, s11, s12
    s_mul_i32 s39, s11, 1152
    s_mul_i32 s12, s44, 384
    s_add_u32 s39, s39, s12
    s_mov_b32 s46, 38912
    s_cmp_eq_u32 s33, 0
    s_cbranch_scc1 K2_NOFF0
    s_lshl_b32 s11, s41, 12
    s_add_u32 s11, s11, s46
    s_mov_b32 m0, s11
    s_mov_b32 s12, s38
    buffer_load_dwordx4 v145, s[24:27], s12 offen offset:0 lds
    buffer_load_dwordx4 v145, s[24:27], s12 offen offset:1024 lds
    buffer_load_dwordx4 v145, s[24:27], s12 offen offset:2048 lds
    buffer_load_dwordx4 v145, s[24:27], s12 offen offset:3072 lds
    s_mul_i32 s11, s41, 6144
    s_add_u32 s11, s11, s46
    s_add_u32 m0, s11, 16384
    s_mov_b32 s12, s39
    buffer_load_dwordx4 v147, s[28:31], s12 offen lds
    s_add_u32 m0, m0, 1024
    s_nop 0
    buffer_load_dwordx4 v148, s[28:31], s12 offen lds
    s_add_u32 m0, m0, 1024
    s_nop 0
    buffer_load_dwordx4 v149, s[28:31], s12 offen lds
    s_add_u32 m0, m0, 1024
    s_add_u32 s12, s12, 9216
    buffer_load_dwordx4 v147, s[28:31], s12 offen lds
    s_add_u32 m0, m0, 1024
    s_nop 0
    buffer_load_dwordx4 v148, s[28:31], s12 offen lds
    s_add_u32 m0, m0, 1024
    s_nop 0
    buffer_load_dwordx4 v149, s[28:31], s12 offen lds
    s_add_u32 m0, m0, 1024
    s_add_u32 s12, s12, 9216
    s_add_u32 s38, s38, 4096
    s_add_u32 s39, s39, 73728
    s_add_u32 s46, s46, 40960
    s_cmp_ge_u32 s46, 161792
    s_cselect_b32 s46, 38912, s46
K2_NOFF0:
    s_and_b32 s11, s41, 1
    s_lshl_b32 s11, s11, 13
    s_add_u32 s11, s11, 38912
    v_lshlrev_b32 v138, 4, v0
    v_add_u32 v138, s11, v138
    v_lshrrev_b32 v156, 2, v0
    v_and_b32 v156, 3, v156
    v_lshlrev_b32 v157, 2, v155
    v_add_u32 v157, v157, v156
    v_mul_u32_u24 v157, 384, v157
    v_lshrrev_b32 v158, 4, v0
    v_and_b32 v158, 1, v158
    v_lshlrev_b32 v158, 5, v158
    v_add_u32 v157, v157, v158
    v_and_b32 v158, 3, v0
    v_lshlrev_b32 v158, 3, v158
    v_add_u32 v157, v157, v158
    v_add_u32 v157, 38912, v157
    v_lshrrev_b32 v156, 1, v156
    s_lshr_b32 s11, s41, 1
    s_mul_i32 s11, s11, 3
    s_add_u32 s12, s11, 0
    v_xor_b32 v158, s12, v156
    v_lshlrev_b32 v158, 6, v158
    v_add_u32 v142, v157, v158
    s_add_u32 s12, s11, 1
    v_xor_b32 v158, s12, v156
    v_lshlrev_b32 v158, 6, v158
    v_add_u32 v143, v157, v158
    s_add_u32 s12, s11, 2
    v_xor_b32 v158, s12, v156
    v_lshlrev_b32 v158, 6, v158
    v_add_u32 v144, v157, v158
    v_mov_b32 v2, 0
    v_mov_b32 v3, 0
    v_mov_b32 v4, 0
    v_mov_b32 v5, 0
    v_mov_b32 v6, 0
    v_mov_b32 v7, 0
    v_mov_b32 v8, 0
    v_mov_b32 v9, 0
    v_mov_b32 v10, 0
    v_mov_b32 v11, 0
    v_mov_b32 v12, 0
    v_mov_b32 v13, 0
    v_mov_b32 v14, 0
    v_mov_b32 v15, 0
    v_mov_b32 v16, 0
    v_mov_b32 v17, 0
    v_mov_b32 v18, 0
    v_mov_b32 v19, 0
    v_mov_b32 v20, 0
    v_mov_b32 v21, 0
    v_mov_b32 v22, 0
    v_mov_b32 v23, 0
    v_mov_b32 v24, 0
    v_mov_b32 v25, 0
    v_mov_b32 v26, 0
    v_mov_b32 v27, 0
    v_mov_b32 v28, 0
    v_mov_b32 v29, 0
    v_mov_b32 v30, 0
    v_mov_b32 v31, 0
    v_mov_b32 v32, 0
    v_mov_b32 v33, 0
    v_mov_b32 v34, 0
    v_mov_b32 v35, 0
    v_mov_b32 v36, 0
    v_mov_b32 v37, 0
    v_mov_b32 v38, 0
    v_mov_b32 v39, 0
    v_mov_b32 v40, 0
    v_mov_b32 v41, 0
    v_mov_b32 v42, 0
    v_mov_b32 v43, 0
    v_mov_b32 v44, 0
    v_mov_b32 v45, 0
    v_mov_b32 v46, 0
    v_mov_b32 v47, 0
    v_mov_b32 v48, 0
    v_mov_b32 v49, 0
    v_mov_b32 v50, 0
    v_mov_b32 v51, 0
    v_mov_b32 v52, 0
    v_mov_b32 v53, 0
    v_mov_b32 v54, 0
    v_mov_b32 v55, 0
    v_mov_b32 v56, 0
    v_mov_b32 v57, 0
    v_mov_b32 v58, 0
    v_mov_b32 v59, 0
    v_mov_b32 v60, 0
    v_mov_b32 v61, 0
    v_mov_b32 v62, 0
    v_mov_b32 v63, 0
    v_mov_b32 v64, 0
    v_mov_b32 v65, 0
    v_mov_b32 v66, 0
    v_mov_b32 v67, 0
    v_mov_b32 v68, 0
    v_mov_b32 v69, 0
    v_mov_b32 v70, 0
    v_mov_b32 v71, 0
    v_mov_b32 v72, 0
    v_mov_b32 v73, 0
    v_mov_b32 v74, 0
    v_mov_b32 v75, 0
    v_mov_b32 v76, 0
    v_mov_b32 v77, 0
    v_mov_b32 v78, 0
    v_mov_b32 v79, 0
    v_mov_b32 v80, 0
    v_mov_b32 v81, 0
    v_mov_b32 v82, 0
    v_mov_b32 v83, 0
    v_mov_b32 v84, 0
    v_mov_b32 v85, 0
    v_mov_b32 v86, 0
    v_mov_b32 v87, 0
    v_mov_b32 v88, 0
    v_mov_b32 v89, 0
    v_mov_b32 v90, 0
    v_mov_b32 v91, 0
    v_mov_b32 v92, 0
    v_mov_b32 v93, 0
    v_mov_b32 v94, 0
    v_mov_b32 v95, 0
    v_mov_b32 v96, 0
    v_mov_b32 v97, 0
    s_cmp_eq_u32 s33, 0
    s_cbranch_scc1 K2_W0A0
    s_waitcnt vmcnt(16)
    s_branch K2_W0A1
K2_W0A0:
    s_waitcnt vmcnt(6)
K2_W0A1:
    s_barrier
    s_cmp_eq_u32 s33, 0
    s_cbranch_scc1 K2_W0B0
    s_waitcnt vmcnt(13)
    s_branch K2_W0B1
K2_W0B0:
    s_waitcnt vmcnt(3)
K2_W0B1:
    s_barrier
    s_mov_b32 s32, 0
    s_mov_b32 s34, 0
K2_PLOOP:
    s_cmp_eq_u32 s32, 15
    s_cbranch_scc0 K2_NOPF3
    s_lshr_b32 s12, s2, 3
    s_lshl_b32 s12, s12, 2
    s_add_u32 s12, s12, s41
    s_getpc_b64 s[20:21]
K2N_PC:
    s_add_u32 s20, s20, k3_out_kernel-K2N_PC
    s_addc_u32 s21, s21, 0-(((k3_out_kernel-K2N_PC)>>63)&1)
    s_mov_b32 s22, K3_CODE_END-k3_out_kernel
    s_mov_b32 s23, 0x00020000
    s_mul_i32 s11, s12, 128
    v_min_u32 v154, 0, v0
    v_lshlrev_b32 v154, 7, v154
    buffer_load_dword v174, v154, s[20:23], s11 offen
    s_mov_b32 s20, s54
    s_mov_b32 s21, s55
    s_mov_b32 s22, 663552
    s_mov_b32 s23, 0x00020000
    s_lshr_b32 s11, s2, 3
    s_lshl_b32 s11, s11, 2
    s_add_u32 s11, s11, s41
    s_mul_i32 s11, s11, 5248
    v_min_u32 v154, 40, v0
    v_lshlrev_b32 v154, 7, v154
    buffer_load_dword v174, v154, s[20:23], s11 offen
    s_mov_b32 s20, s52
    s_mov_b32 s21, s53
    s_mov_b32 s22, 2359296
    s_mov_b32 s23, 0x00020000
    s_and_b32 s11, s2, 7
    s_mul_i32 s11, s11, 294912
    s_lshr_b32 s12, s2, 3
    s_lshl_b32 s12, s12, 2
    s_add_u32 s12, s12, s41
    s_mul_i32 s12, s12, 2304
    s_add_u32 s11, s11, s12
    v_min_u32 v154, 17, v0
    v_lshlrev_b32 v154, 7, v154
    buffer_load_dword v174, v154, s[20:23], s11 offen
K2_NOPF3:
    s_sub_u32 s13, s32, 1
    s_cmp_lt_u32 s13, s33
    s_cbranch_scc0 K2_NOCOMP
    s_add_u32 s13, s32, 1
    s_cmp_lt_u32 s13, s33
    s_cbranch_scc0 K2_NOFF
    s_cmp_lt_u32 s32, 13
    s_cbranch_scc0 K2_FFONLY
    ds_read_b128 v[98:101], v138 offset:0
    ds_read_b128 v[102:105], v138 offset:4096
    ds_read_b64_tr_b16 v[114:115], v142 offset:16384
    ds_read_b64_tr_b16 v[116:117], v142 offset:19456
    ds_read_b64_tr_b16 v[118:119], v143 offset:16384
    ds_read_b64_tr_b16 v[120:121], v143 offset:19456
    ds_read_b64_tr_b16 v[122:123], v144 offset:16384
    ds_read_b64_tr_b16 v[124:125], v144 offset:19456
    s_waitcnt lgkmcnt(0)
    v_mfma_f32_32x32x16_bf16 v[2:17], v[114:117], v[98:101], v[2:17]
    ds_read_b128 v[106:109], v138 offset:1024
    ds_read_b128 v[110:113], v138 offset:5120
    s_lshl_b32 s11, s41, 10
    s_add_u32 s11, s11, s40
    s_add_u32 m0, s11, 512
    v_mfma_f32_32x32x16_bf16 v[50:65], v[114:117], v[102:105], v[50:65]
    ds_read_b64_tr_b16 v[126:127], v142 offset:22528
    ds_read_b64_tr_b16 v[128:129], v142 offset:25600
    s_cmp_eq_u32 s41, 0
    buffer_load_dwordx4 v150, s[16:19], s36 offen lds
    s_mov_b32 s12, 4096
    v_mfma_f32_32x32x16_bf16 v[18:33], v[118:121], v[98:101], v[18:33]
    ds_read_b64_tr_b16 v[130:131], v143 offset:22528
    ds_read_b64_tr_b16 v[132:133], v143 offset:25600
    s_cselect_b32 s12, 8192, s12
    s_add_u32 m0, m0, 4096
    s_add_u32 s12, s12, s11
    v_mfma_f32_32x32x16_bf16 v[66:81], v[118:121], v[102:105], v[66:81]
    ds_read_b64_tr_b16 v[134:135], v144 offset:22528
    ds_read_b64_tr_b16 v[136:137], v144 offset:25600
    buffer_load_dwordx4 v151, s[16:19], s36 offen lds
    s_add_u32 m0, s12, 512
    s_add_u32 s40, s40, 9728
    v_mfma_f32_32x32x16_bf16 v[34:49], v[122:125], v[98:101], v[34:49]
    buffer_load_dwordx4 v152, s[16:19], s36 offen lds
    s_add_u32 s36, s36, 1024
    s_cmp_ge_u32 s40, 38912
    v_mfma_f32_32x32x16_bf16 v[82:97], v[122:125], v[102:105], v[82:97]
    s_cselect_b32 s40, 0, s40
    s_lshl_b32 s11, s41, 12
    s_add_u32 s11, s11, s46
    s_waitcnt lgkmcnt(0)
    v_mfma_f32_32x32x16_bf16 v[2:17], v[126:129], v[106:109], v[2:17]
    ds_read_b128 v[98:101], v138 offset:2048
    ds_read_b128 v[102:105], v138 offset:6144
    s_mov_b32 m0, s11
    s_mov_b32 s12, s38
    buffer_load_dwordx4 v145, s[24:27], s12 offen offset:0 lds
    v_mfma_f32_32x32x16_bf16 v[50:65], v[126:129], v[110:113], v[50:65]
    ds_read_b64_tr_b16 v[114:115], v142 offset:28672
    ds_read_b64_tr_b16 v[116:117], v142 offset:31744
    buffer_load_dwordx4 v145, s[24:27], s12 offen offset:1024 lds
    buffer_load_dwordx4 v145, s[24:27], s12 offen offset:2048 lds
    buffer_load_dwordx4 v145, s[24:27], s12 offen offset:3072 lds
    v_mfma_f32_32x32x16_bf16 v[18:33], v[130:133], v[106:109], v[18:33]
    ds_read_b64_tr_b16 v[118:119], v143 offset:28672
    ds_read_b64_tr_b16 v[120:121], v143 offset:31744
    s_mul_i32 s11, s41, 6144
    s_add_u32 s11, s11, s46
    s_add_u32 m0, s11, 16384
    v_mfma_f32_32x32x16_bf16 v[66:81], v[130:133], v[110:113], v[66:81]
    ds_read_b64_tr_b16 v[122:123], v144 offset:28672
    ds_read_b64_tr_b16 v[124:125], v144 offset:31744
    s_mov_b32 s12, s39
    buffer_load_dwordx4 v147, s[28:31], s12 offen lds
    s_add_u32 m0, m0, 1024
    v_mfma_f32_32x32x16_bf16 v[34:49], v[134:137], v[106:109], v[34:49]
    s_nop 0
    buffer_load_dwordx4 v148, s[28:31], s12 offen lds
    s_add_u32 m0, m0, 1024
    v_mfma_f32_32x32x16_bf16 v[82:97], v[134:137], v[110:113], v[82:97]
    s_nop 0
    buffer_load_dwordx4 v149, s[28:31], s12 offen lds
    s_add_u32 m0, m0, 1024
    s_waitcnt lgkmcnt(0)
    v_mfma_f32_32x32x16_bf16 v[2:17], v[114:117], v[98:101], v[2:17]
    ds_read_b128 v[106:109], v138 offset:3072
    ds_read_b128 v[110:113], v138 offset:7168
    s_add_u32 s12, s12, 9216
    buffer_load_dwordx4 v147, s[28:31], s12 offen lds
    s_add_u32 m0, m0, 1024
    v_mfma_f32_32x32x16_bf16 v[50:65], v[114:117], v[102:105], v[50:65]
    ds_read_b64_tr_b16 v[126:127], v142 offset:34816
    ds_read_b64_tr_b16 v[128:129], v142 offset:37888
    s_nop 0
    buffer_load_dwordx4 v148, s[28:31], s12 offen lds
    s_add_u32 m0, m0, 1024
    v_mfma_f32_32x32x16_bf16 v[18:33], v[118:121], v[98:101], v[18:33]
    ds_read_b64_tr_b16 v[130:131], v143 offset:34816
    ds_read_b64_tr_b16 v[132:133], v143 offset:37888
    s_nop 0
    buffer_load_dwordx4 v149, s[28:31], s12 offen lds
    s_add_u32 m0, m0, 1024
    v_mfma_f32_32x32x16_bf16 v[66:81], v[118:121], v[102:105], v[66:81]
    ds_read_b64_tr_b16 v[134:135], v144 offset:34816
    ds_read_b64_tr_b16 v[136:137], v144 offset:37888
    s_add_u32 s12, s12, 9216
    s_add_u32 s38, s38, 4096
    s_add_u32 s39, s39, 73728
    v_mfma_f32_32x32x16_bf16 v[34:49], v[122:125], v[98:101], v[34:49]
    s_add_u32 s46, s46, 40960
    s_cmp_ge_u32 s46, 161792
    s_cselect_b32 s46, 38912, s46
    v_mfma_f32_32x32x16_bf16 v[82:97], v[122:125], v[102:105], v[82:97]
    s_waitcnt lgkmcnt(0)
    v_mfma_f32_32x32x16_bf16 v[2:17], v[126:129], v[106:109], v[2:17]
    v_mfma_f32_32x32x16_bf16 v[50:65], v[126:129], v[110:113], v[50:65]
    v_mfma_f32_32x32x16_bf16 v[18:33], v[130:133], v[106:109], v[18:33]
    v_mfma_f32_32x32x16_bf16 v[66:81], v[130:133], v[110:113], v[66:81]
    v_mfma_f32_32x32x16_bf16 v[34:49], v[134:137], v[106:109], v[34:49]
    v_mfma_f32_32x32x16_bf16 v[82:97], v[134:137], v[110:113], v[82:97]
    s_waitcnt vmcnt(13)
    s_branch K2_ADV
K2_FFONLY:
    ds_read_b128 v[98:101], v138 offset:0
    ds_read_b128 v[102:105], v138 offset:4096
    ds_read_b64_tr_b16 v[114:115], v142 offset:16384
    ds_read_b64_tr_b16 v[116:117], v142 offset:19456
    ds_read_b64_tr_b16 v[118:119], v143 offset:16384
    ds_read_b64_tr_b16 v[120:121], v143 offset:19456
    ds_read_b64_tr_b16 v[122:123], v144 offset:16384
    ds_read_b64_tr_b16 v[124:125], v144 offset:19456
    s_waitcnt lgkmcnt(0)
    v_mfma_f32_32x32x16_bf16 v[2:17], v[114:117], v[98:101], v[2:17]
    ds_read_b128 v[106:109], v138 offset:1024
    ds_read_b128 v[110:113], v138 offset:5120
    s_lshl_b32 s11, s41, 12
    s_add_u32 s11, s11, s46
    v_mfma_f32_32x32x16_bf16 v[50:65], v[114:117], v[102:105], v[50:65]
    ds_read_b64_tr_b16 v[126:127], v142 offset:22528
    ds_read_b64_tr_b16 v[128:129], v142 offset:25600
    s_mov_b32 m0, s11
    s_mov_b32 s12, s38
    v_mfma_f32_32x32x16_bf16 v[18:33], v[118:121], v[98:101], v[18:33]
    ds_read_b64_tr_b16 v[130:131], v143 offset:22528
    ds_read_b64_tr_b16 v[132:133], v143 offset:25600
    buffer_load_dwordx4 v145, s[24:27], s12 offen offset:0 lds
    buffer_load_dwordx4 v145, s[24:27], s12 offen offset:1024 lds
    v_mfma_f32_32x32x16_bf16 v[66:81], v[118:121], v[102:105], v[66:81]
    ds_read_b64_tr_b16 v[134:135], v144 offset:22528
    ds_read_b64_tr_b16 v[136:137], v144 offset:25600
    buffer_load_dwordx4 v145, s[24:27], s12 offen offset:2048 lds
    buffer_load_dwordx4 v145, s[24:27], s12 offen offset:3072 lds
    v_mfma_f32_32x32x16_bf16 v[34:49], v[122:125], v[98:101], v[34:49]
    s_mul_i32 s11, s41, 6144
    s_add_u32 s11, s11, s46
    v_mfma_f32_32x32x16_bf16 v[82:97], v[122:125], v[102:105], v[82:97]
    s_add_u32 m0, s11, 16384
    s_mov_b32 s12, s39
    s_waitcnt lgkmcnt(0)
    v_mfma_f32_32x32x16_bf16 v[2:17], v[126:129], v[106:109], v[2:17]
    ds_read_b128 v[98:101], v138 offset:2048
    ds_read_b128 v[102:105], v138 offset:6144
    buffer_load_dwordx4 v147, s[28:31], s12 offen lds
    s_add_u32 m0, m0, 1024
    v_mfma_f32_32x32x16_bf16 v[50:65], v[126:129], v[110:113], v[50:65]
    ds_read_b64_tr_b16 v[114:115], v142 offset:28672
    ds_read_b64_tr_b16 v[116:117], v142 offset:31744
    s_nop 0
    buffer_load_dwordx4 v148, s[28:31], s12 offen lds
    v_mfma_f32_32x32x16_bf16 v[18:33], v[130:133], v[106:109], v[18:33]
    ds_read_b64_tr_b16 v[118:119], v143 offset:28672
    ds_read_b64_tr_b16 v[120:121], v143 offset:31744
    s_add_u32 m0, m0, 1024
    s_nop 0
    v_mfma_f32_32x32x16_bf16 v[66:81], v[130:133], v[110:113], v[66:81]
    ds_read_b64_tr_b16 v[122:123], v144 offset:28672
    ds_read_b64_tr_b16 v[124:125], v144 offset:31744
    buffer_load_dwordx4 v149, s[28:31], s12 offen lds
    s_add_u32 m0, m0, 1024
    v_mfma_f32_32x32x16_bf16 v[34:49], v[134:137], v[106:109], v[34:49]
    s_add_u32 s12, s12, 9216
    buffer_load_dwordx4 v147, s[28:31], s12 offen lds
    v_mfma_f32_32x32x16_bf16 v[82:97], v[134:137], v[110:113], v[82:97]
    s_add_u32 m0, m0, 1024
    s_nop 0
    s_waitcnt lgkmcnt(0)
    v_mfma_f32_32x32x16_bf16 v[2:17], v[114:117], v[98:101], v[2:17]
    ds_read_b128 v[106:109], v138 offset:3072
    ds_read_b128 v[110:113], v138 offset:7168
    buffer_load_dwordx4 v148, s[28:31], s12 offen lds
    s_add_u32 m0, m0, 1024
    v_mfma_f32_32x32x16_bf16 v[50:65], v[114:117], v[102:105], v[50:65]
    ds_read_b64_tr_b16 v[126:127], v142 offset:34816
    ds_read_b64_tr_b16 v[128:129], v142 offset:37888
    s_nop 0
    buffer_load_dwordx4 v149, s[28:31], s12 offen lds
    v_mfma_f32_32x32x16_bf16 v[18:33], v[118:121], v[98:101], v[18:33]
    ds_read_b64_tr_b16 v[130:131], v143 offset:34816
    ds_read_b64_tr_b16 v[132:133], v143 offset:37888
    s_add_u32 m0, m0, 1024
    s_add_u32 s12, s12, 9216
    v_mfma_f32_32x32x16_bf16 v[66:81], v[118:121], v[102:105], v[66:81]
    ds_read_b64_tr_b16 v[134:135], v144 offset:34816
    ds_read_b64_tr_b16 v[136:137], v144 offset:37888
    s_add_u32 s38, s38, 4096
    s_add_u32 s39, s39, 73728
    v_mfma_f32_32x32x16_bf16 v[34:49], v[122:125], v[98:101], v[34:49]
    s_add_u32 s46, s46, 40960
    s_cmp_ge_u32 s46, 161792
    v_mfma_f32_32x32x16_bf16 v[82:97], v[122:125], v[102:105], v[82:97]
    s_cselect_b32 s46, 38912, s46
    s_waitcnt lgkmcnt(0)
    v_mfma_f32_32x32x16_bf16 v[2:17], v[126:129], v[106:109], v[2:17]
    v_mfma_f32_32x32x16_bf16 v[50:65], v[126:129], v[110:113], v[50:65]
    v_mfma_f32_32x32x16_bf16 v[18:33], v[130:133], v[106:109], v[18:33]
    v_mfma_f32_32x32x16_bf16 v[66:81], v[130:133], v[110:113], v[66:81]
    v_mfma_f32_32x32x16_bf16 v[34:49], v[134:137], v[106:109], v[34:49]
    v_mfma_f32_32x32x16_bf16 v[82:97], v[134:137], v[110:113], v[82:97]
    s_waitcnt vmcnt(10)
    s_branch K2_ADV
K2_NOFF:
    s_cmp_lt_u32 s32, 13
    s_cbranch_scc0 K2_COMPONLY
    ds_read_b128 v[98:101], v138 offset:0
    ds_read_b128 v[102:105], v138 offset:4096
    ds_read_b64_tr_b16 v[114:115], v142 offset:16384
    ds_read_b64_tr_b16 v[116:117], v142 offset:19456
    ds_read_b64_tr_b16 v[118:119], v143 offset:16384
    ds_read_b64_tr_b16 v[120:121], v143 offset:19456
    ds_read_b64_tr_b16 v[122:123], v144 offset:16384
    ds_read_b64_tr_b16 v[124:125], v144 offset:19456
    s_waitcnt lgkmcnt(0)
    v_mfma_f32_32x32x16_bf16 v[2:17], v[114:117], v[98:101], v[2:17]
    ds_read_b128 v[106:109], v138 offset:1024
    ds_read_b128 v[110:113], v138 offset:5120
    s_lshl_b32 s11, s41, 10
    v_mfma_f32_32x32x16_bf16 v[50:65], v[114:117], v[102:105], v[50:65]
    ds_read_b64_tr_b16 v[126:127], v142 offset:22528
    ds_read_b64_tr_b16 v[128:129], v142 offset:25600
    s_add_u32 s11, s11, s40
    v_mfma_f32_32x32x16_bf16 v[18:33], v[118:121], v[98:101], v[18:33]
    ds_read_b64_tr_b16 v[130:131], v143 offset:22528
    ds_read_b64_tr_b16 v[132:133], v143 offset:25600
    s_add_u32 m0, s11, 512
    v_mfma_f32_32x32x16_bf16 v[66:81], v[118:121], v[102:105], v[66:81]
    ds_read_b64_tr_b16 v[134:135], v144 offset:22528
    ds_read_b64_tr_b16 v[136:137], v144 offset:25600
    s_cmp_eq_u32 s41, 0
    v_mfma_f32_32x32x16_bf16 v[34:49], v[122:125], v[98:101], v[34:49]
    buffer_load_dwordx4 v150, s[16:19], s36 offen lds
    v_mfma_f32_32x32x16_bf16 v[82:97], v[122:125], v[102:105], v[82:97]
    s_mov_b32 s12, 4096
    s_waitcnt lgkmcnt(0)
    v_mfma_f32_32x32x16_bf16 v[2:17], v[126:129], v[106:109], v[2:17]
    ds_read_b128 v[98:101], v138 offset:2048
    ds_read_b128 v[102:105], v138 offset:6144
    s_cselect_b32 s12, 8192, s12
    v_mfma_f32_32x32x16_bf16 v[50:65], v[126:129], v[110:113], v[50:65]
    ds_read_b64_tr_b16 v[114:115], v142 offset:28672
    ds_read_b64_tr_b16 v[116:117], v142 offset:31744
    s_add_u32 m0, m0, 4096
    v_mfma_f32_32x32x16_bf16 v[18:33], v[130:133], v[106:109], v[18:33]
    ds_read_b64_tr_b16 v[118:119], v143 offset:28672
    ds_read_b64_tr_b16 v[120:121], v143 offset:31744
    s_add_u32 s12, s12, s11
    v_mfma_f32_32x32x16_bf16 v[66:81], v[130:133], v[110:113], v[66:81]
    ds_read_b64_tr_b16 v[122:123], v144 offset:28672
    ds_read_b64_tr_b16 v[124:125], v144 offset:31744
    buffer_load_dwordx4 v151, s[16:19], s36 offen lds
    v_mfma_f32_32x32x16_bf16 v[34:49], v[134:137], v[106:109], v[34:49]
    s_add_u32 m0, s12, 512
    v_mfma_f32_32x32x16_bf16 v[82:97], v[134:137], v[110:113], v[82:97]
    s_add_u32 s40, s40, 9728
    s_waitcnt lgkmcnt(0)
    v_mfma_f32_32x32x16_bf16 v[2:17], v[114:117], v[98:101], v[2:17]
    ds_read_b128 v[106:109], v138 offset:3072
    ds_read_b128 v[110:113], v138 offset:7168
    buffer_load_dwordx4 v152, s[16:19], s36 offen lds
    v_mfma_f32_32x32x16_bf16 v[50:65], v[114:117], v[102:105], v[50:65]
    ds_read_b64_tr_b16 v[126:127], v142 offset:34816
    ds_read_b64_tr_b16 v[128:129], v142 offset:37888
    s_add_u32 s36, s36, 1024
    v_mfma_f32_32x32x16_bf16 v[18:33], v[118:121], v[98:101], v[18:33]
    ds_read_b64_tr_b16 v[130:131], v143 offset:34816
    ds_read_b64_tr_b16 v[132:133], v143 offset:37888
    s_cmp_ge_u32 s40, 38912
    v_mfma_f32_32x32x16_bf16 v[66:81], v[118:121], v[102:105], v[66:81]
    ds_read_b64_tr_b16 v[134:135], v144 offset:34816
    ds_read_b64_tr_b16 v[136:137], v144 offset:37888
    s_cselect_b32 s40, 0, s40
    v_mfma_f32_32x32x16_bf16 v[34:49], v[122:125], v[98:101], v[34:49]
    v_mfma_f32_32x32x16_bf16 v[82:97], v[122:125], v[102:105], v[82:97]
    s_waitcnt lgkmcnt(0)
    v_mfma_f32_32x32x16_bf16 v[2:17], v[126:129], v[106:109], v[2:17]
    v_mfma_f32_32x32x16_bf16 v[50:65], v[126:129], v[110:113], v[50:65]
    v_mfma_f32_32x32x16_bf16 v[18:33], v[130:133], v[106:109], v[18:33]
    v_mfma_f32_32x32x16_bf16 v[66:81], v[130:133], v[110:113], v[66:81]
    v_mfma_f32_32x32x16_bf16 v[34:49], v[134:137], v[106:109], v[34:49]
    v_mfma_f32_32x32x16_bf16 v[82:97], v[134:137], v[110:113], v[82:97]
    s_waitcnt vmcnt(3)
    s_branch K2_ADV
K2_COMPONLY:
    ds_read_b128 v[98:101], v138 offset:0
    ds_read_b128 v[102:105], v138 offset:4096
    ds_read_b64_tr_b16 v[114:115], v142 offset:16384
    ds_read_b64_tr_b16 v[116:117], v142 offset:19456
    ds_read_b64_tr_b16 v[118:119], v143 offset:16384
    ds_read_b64_tr_b16 v[120:121], v143 offset:19456
    ds_read_b64_tr_b16 v[122:123], v144 offset:16384
    ds_read_b64_tr_b16 v[124:125], v144 offset:19456
    s_waitcnt lgkmcnt(0)
    v_mfma_f32_32x32x16_bf16 v[2:17], v[114:117], v[98:101], v[2:17]
    ds_read_b128 v[106:109], v138 offset:1024
    ds_read_b128 v[110:113], v138 offset:5120
    v_mfma_f32_32x32x16_bf16 v[50:65], v[114:117], v[102:105], v[50:65]
    ds_read_b64_tr_b16 v[126:127], v142 offset:22528
    ds_read_b64_tr_b16 v[128:129], v142 offset:25600
    v_mfma_f32_32x32x16_bf16 v[18:33], v[118:121], v[98:101], v[18:33]
    ds_read_b64_tr_b16 v[130:131], v143 offset:22528
    ds_read_b64_tr_b16 v[132:133], v143 offset:25600
    v_mfma_f32_32x32x16_bf16 v[66:81], v[118:121], v[102:105], v[66:81]
    ds_read_b64_tr_b16 v[134:135], v144 offset:22528
    ds_read_b64_tr_b16 v[136:137], v144 offset:25600
    v_mfma_f32_32x32x16_bf16 v[34:49], v[122:125], v[98:101], v[34:49]
    v_mfma_f32_32x32x16_bf16 v[82:97], v[122:125], v[102:105], v[82:97]
    s_waitcnt lgkmcnt(0)
    v_mfma_f32_32x32x16_bf16 v[2:17], v[126:129], v[106:109], v[2:17]
    ds_read_b128 v[98:101], v138 offset:2048
    ds_read_b128 v[102:105], v138 offset:6144
    v_mfma_f32_32x32x16_bf16 v[50:65], v[126:129], v[110:113], v[50:65]
    ds_read_b64_tr_b16 v[114:115], v142 offset:28672
    ds_read_b64_tr_b16 v[116:117], v142 offset:31744
    v_mfma_f32_32x32x16_bf16 v[18:33], v[130:133], v[106:109], v[18:33]
    ds_read_b64_tr_b16 v[118:119], v143 offset:28672
    ds_read_b64_tr_b16 v[120:121], v143 offset:31744
    v_mfma_f32_32x32x16_bf16 v[66:81], v[130:133], v[110:113], v[66:81]
    ds_read_b64_tr_b16 v[122:123], v144 offset:28672
    ds_read_b64_tr_b16 v[124:125], v144 offset:31744
    v_mfma_f32_32x32x16_bf16 v[34:49], v[134:137], v[106:109], v[34:49]
    v_mfma_f32_32x32x16_bf16 v[82:97], v[134:137], v[110:113], v[82:97]
    s_waitcnt lgkmcnt(0)
    v_mfma_f32_32x32x16_bf16 v[2:17], v[114:117], v[98:101], v[2:17]
    ds_read_b128 v[106:109], v138 offset:3072
    ds_read_b128 v[110:113], v138 offset:7168
    v_mfma_f32_32x32x16_bf16 v[50:65], v[114:117], v[102:105], v[50:65]
    ds_read_b64_tr_b16 v[126:127], v142 offset:34816
    ds_read_b64_tr_b16 v[128:129], v142 offset:37888
    v_mfma_f32_32x32x16_bf16 v[18:33], v[118:121], v[98:101], v[18:33]
    ds_read_b64_tr_b16 v[130:131], v143 offset:34816
    ds_read_b64_tr_b16 v[132:133], v143 offset:37888
    v_mfma_f32_32x32x16_bf16 v[66:81], v[118:121], v[102:105], v[66:81]
    ds_read_b64_tr_b16 v[134:135], v144 offset:34816
    ds_read_b64_tr_b16 v[136:137], v144 offset:37888
    v_mfma_f32_32x32x16_bf16 v[34:49], v[122:125], v[98:101], v[34:49]
    v_mfma_f32_32x32x16_bf16 v[82:97], v[122:125], v[102:105], v[82:97]
    s_waitcnt lgkmcnt(0)
    v_mfma_f32_32x32x16_bf16 v[2:17], v[126:129], v[106:109], v[2:17]
    v_mfma_f32_32x32x16_bf16 v[50:65], v[126:129], v[110:113], v[50:65]
    v_mfma_f32_32x32x16_bf16 v[18:33], v[130:133], v[106:109], v[18:33]
    v_mfma_f32_32x32x16_bf16 v[66:81], v[130:133], v[110:113], v[66:81]
    v_mfma_f32_32x32x16_bf16 v[34:49], v[134:137], v[106:109], v[34:49]
    v_mfma_f32_32x32x16_bf16 v[82:97], v[134:137], v[110:113], v[82:97]
    s_waitcnt vmcnt(0)
K2_ADV:
    s_add_u32 s34, s34, 1
    s_mov_b32 s12, 40960
    s_cmp_eq_u32 s34, 3
    s_cselect_b32 s11, 4294885376, s12
    s_cselect_b32 s34, 0, s34
    v_add_u32 v138, s11, v138
    v_add_u32 v142, s11, v142
    v_add_u32 v143, s11, v143
    v_add_u32 v144, s11, v144
    s_branch K2_BAR
K2_NOCOMP:
    s_add_u32 s13, s32, 1
    s_cmp_lt_u32 s13, s33
    s_cbranch_scc0 K2_NC_NOFF
    s_lshl_b32 s11, s41, 10
    s_add_u32 s11, s11, s40
    s_add_u32 m0, s11, 512
    s_cmp_eq_u32 s41, 0
    buffer_load_dwordx4 v150, s[16:19], s36 offen lds
    s_mov_b32 s12, 4096
    s_cselect_b32 s12, 8192, s12
    s_add_u32 m0, m0, 4096
    s_add_u32 s12, s12, s11
    buffer_load_dwordx4 v151, s[16:19], s36 offen lds
    s_add_u32 m0, s12, 512
    s_add_u32 s40, s40, 9728
    buffer_load_dwordx4 v152, s[16:19], s36 offen lds
    s_add_u32 s36, s36, 1024
    s_cmp_ge_u32 s40, 38912
    s_cselect_b32 s40, 0, s40
    s_lshl_b32 s11, s41, 12
    s_add_u32 s11, s11, s46
    s_mov_b32 m0, s11
    s_mov_b32 s12, s38
    buffer_load_dwordx4 v145, s[24:27], s12 offen offset:0 lds
    buffer_load_dwordx4 v145, s[24:27], s12 offen offset:1024 lds
    buffer_load_dwordx4 v145, s[24:27], s12 offen offset:2048 lds
    buffer_load_dwordx4 v145, s[24:27], s12 offen offset:3072 lds
    s_mul_i32 s11, s41, 6144
    s_add_u32 s11, s11, s46
    s_add_u32 m0, s11, 16384
    s_mov_b32 s12, s39
    buffer_load_dwordx4 v147, s[28:31], s12 offen lds
    s_add_u32 m0, m0, 1024
    s_nop 0
    buffer_load_dwordx4 v148, s[28:31], s12 offen lds
    s_add_u32 m0, m0, 1024
    s_nop 0
    buffer_load_dwordx4 v149, s[28:31], s12 offen lds
    s_add_u32 m0, m0, 1024
    s_add_u32 s12, s12, 9216
    buffer_load_dwordx4 v147, s[28:31], s12 offen lds
    s_add_u32 m0, m0, 1024
    s_nop 0
    buffer_load_dwordx4 v148, s[28:31], s12 offen lds
    s_add_u32 m0, m0, 1024
    s_nop 0
    buffer_load_dwordx4 v149, s[28:31], s12 offen lds
    s_add_u32 m0, m0, 1024
    s_add_u32 s12, s12, 9216
    s_add_u32 s38, s38, 4096
    s_add_u32 s39, s39, 73728
    s_add_u32 s46, s46, 40960
    s_cmp_ge_u32 s46, 161792
    s_cselect_b32 s46, 38912, s46
    s_waitcnt vmcnt(13)
    s_branch K2_BAR
K2_NC_NOFF:
    s_cmp_lt_u32 s32, 13
    s_cbranch_scc0 K2_WAIT0
    s_lshl_b32 s11, s41, 10
    s_add_u32 s11, s11, s40
    s_add_u32 m0, s11, 512
    s_cmp_eq_u32 s41, 0
    buffer_load_dwordx4 v150, s[16:19], s36 offen lds
    s_mov_b32 s12, 4096
    s_cselect_b32 s12, 8192, s12
    s_add_u32 m0, m0, 4096
    s_add_u32 s12, s12, s11
    buffer_load_dwordx4 v151, s[16:19], s36 offen lds
    s_add_u32 m0, s12, 512
    s_add_u32 s40, s40, 9728
    buffer_load_dwordx4 v152, s[16:19], s36 offen lds
    s_add_u32 s36, s36, 1024
    s_cmp_ge_u32 s40, 38912
    s_cselect_b32 s40, 0, s40
    s_waitcnt vmcnt(3)
    s_branch K2_BAR
K2_WAIT0:
    s_waitcnt vmcnt(0)
K2_BAR:
    s_barrier
    s_add_u32 s32, s32, 1
    s_cmp_lt_u32 s32, 16
    s_cbranch_scc1 K2_PLOOP
    s_cmp_eq_u32 s33, 0
    s_cbranch_scc1 K2_PEND
    s_add_u32 s24, s6, 26007552
    s_addc_u32 s25, s7, 0
    s_mov_b32 s26, 11796480
    s_mov_b32 s27, 0x00020000
    s_and_b32 s11, s41, 1
    s_lshl_b32 s11, s11, 1
    s_lshl_b32 s12, s43, 2
    s_add_u32 s11, s11, s12
    s_mul_i32 s11, s11, 18
    s_mul_i32 s12, s44, 6
    s_add_u32 s11, s11, s12
    s_lshr_b32 s12, s41, 1
    s_mul_i32 s12, s12, 3
    s_add_u32 s11, s11, s12
    s_lshl_b32 s11, s11, 11
    s_mul_i32 s12, s42, 2359296
    s_add_u32 s11, s11, s12
    v_lshlrev_b32 v154, 4, v0
    v_cvt_pk_bf16_f32 v98, v2, v3
    v_cvt_pk_bf16_f32 v99, v4, v5
    v_cvt_pk_bf16_f32 v100, v6, v7
    v_cvt_pk_bf16_f32 v101, v8, v9
    v_cvt_pk_bf16_f32 v102, v10, v11
    v_cvt_pk_bf16_f32 v103, v12, v13
    v_cvt_pk_bf16_f32 v104, v14, v15
    v_cvt_pk_bf16_f32 v105, v16, v17
    s_add_u32 s12, s11, 0
    buffer_store_dwordx4 v[98:101], v154, s[24:27], s12 offen sc1
    buffer_store_dwordx4 v[102:105], v154, s[24:27], s12 offen offset:1024 sc1
    v_cvt_pk_bf16_f32 v106, v18, v19
    v_cvt_pk_bf16_f32 v107, v20, v21
    v_cvt_pk_bf16_f32 v108, v22, v23
    v_cvt_pk_bf16_f32 v109, v24, v25
    v_cvt_pk_bf16_f32 v110, v26, v27
    v_cvt_pk_bf16_f32 v111, v28, v29
    v_cvt_pk_bf16_f32 v112, v30, v31
    v_cvt_pk_bf16_f32 v113, v32, v33
    s_add_u32 s12, s11, 2048
    buffer_store_dwordx4 v[106:109], v154, s[24:27], s12 offen sc1
    buffer_store_dwordx4 v[110:113], v154, s[24:27], s12 offen offset:1024 sc1
    v_cvt_pk_bf16_f32 v98, v34, v35
    v_cvt_pk_bf16_f32 v99, v36, v37
    v_cvt_pk_bf16_f32 v100, v38, v39
    v_cvt_pk_bf16_f32 v101, v40, v41
    v_cvt_pk_bf16_f32 v102, v42, v43
    v_cvt_pk_bf16_f32 v103, v44, v45
    v_cvt_pk_bf16_f32 v104, v46, v47
    v_cvt_pk_bf16_f32 v105, v48, v49
    s_add_u32 s12, s11, 4096
    buffer_store_dwordx4 v[98:101], v154, s[24:27], s12 offen sc1
    buffer_store_dwordx4 v[102:105], v154, s[24:27], s12 offen offset:1024 sc1
    v_cvt_pk_bf16_f32 v106, v50, v51
    v_cvt_pk_bf16_f32 v107, v52, v53
    v_cvt_pk_bf16_f32 v108, v54, v55
    v_cvt_pk_bf16_f32 v109, v56, v57
    v_cvt_pk_bf16_f32 v110, v58, v59
    v_cvt_pk_bf16_f32 v111, v60, v61
    v_cvt_pk_bf16_f32 v112, v62, v63
    v_cvt_pk_bf16_f32 v113, v64, v65
    s_add_u32 s12, s11, 36864
    buffer_store_dwordx4 v[106:109], v154, s[24:27], s12 offen sc1
    buffer_store_dwordx4 v[110:113], v154, s[24:27], s12 offen offset:1024 sc1
    v_cvt_pk_bf16_f32 v98, v66, v67
    v_cvt_pk_bf16_f32 v99, v68, v69
    v_cvt_pk_bf16_f32 v100, v70, v71
    v_cvt_pk_bf16_f32 v101, v72, v73
    v_cvt_pk_bf16_f32 v102, v74, v75
    v_cvt_pk_bf16_f32 v103, v76, v77
    v_cvt_pk_bf16_f32 v104, v78, v79
    v_cvt_pk_bf16_f32 v105, v80, v81
    s_add_u32 s12, s11, 38912
    buffer_store_dwordx4 v[98:101], v154, s[24:27], s12 offen sc1
    buffer_store_dwordx4 v[102:105], v154, s[24:27], s12 offen offset:1024 sc1
    v_cvt_pk_bf16_f32 v106, v82, v83
    v_cvt_pk_bf16_f32 v107, v84, v85
    v_cvt_pk_bf16_f32 v108, v86, v87
    v_cvt_pk_bf16_f32 v109, v88, v89
    v_cvt_pk_bf16_f32 v110, v90, v91
    v_cvt_pk_bf16_f32 v111, v92, v93
    v_cvt_pk_bf16_f32 v112, v94, v95
    v_cvt_pk_bf16_f32 v113, v96, v97
    s_add_u32 s12, s11, 40960
    buffer_store_dwordx4 v[106:109], v154, s[24:27], s12 offen sc1
    buffer_store_dwordx4 v[110:113], v154, s[24:27], s12 offen offset:1024 sc1
K2_PEND:
    s_endpgm
K2_END:
    s_endpgm
K2_CODE_END:

.globl k3_out_kernel
.p2align 8
.type k3_out_kernel,@function
k3_out_kernel:

    s_cmp_ge_u32 s2, 216
    s_cbranch_scc1 K3_END
    s_load_dwordx2 s[4:5], s[0:1], 0
    s_load_dwordx2 s[6:7], s[0:1], 16
    s_load_dwordx2 s[8:9], s[0:1], 56
    s_load_dwordx2 s[10:11], s[0:1], 72
    v_lshrrev_b32 v1, 6, v0
    v_and_b32 v0, 63, v0
    v_readfirstlane_b32 s12, v1
    s_nop 3
    s_lshr_b32 s32, s2, 3
    s_getpc_b64 s[40:41]
K3_PC:
    s_add_u32 s40, s40, k3_out_kernel-K3_PC
    s_addc_u32 s41, s41, 0-(((k3_out_kernel-K3_PC)>>63)&1)
    s_mov_b32 s42, K3_CODE_END-k3_out_kernel
    s_mov_b32 s43, 0x00020000
    s_mul_i32 s15, s32, 384
    v_min_u32 v4, 2, v0
    v_lshlrev_b32 v4, 7, v4
    buffer_load_dword v208, v4, s[40:43], s15 offen
    s_lshr_b32 s15, s2, 3
    s_mul_hi_u32 s32, s15, 477218589
    s_mul_i32 s14, s32, 9
    s_sub_u32 s14, s15, s14
    s_and_b32 s13, s2, 7
    s_lshl_b32 s13, s13, 3
    s_mul_i32 s15, s32, 3
    s_add_u32 s13, s13, s15
    s_mov_b32 s44, s32
    s_lshr_b32 s15, s12, 1
    s_cmp_eq_u32 s44, 2
    s_cselect_b32 s32, 2, 3
    s_cmp_ge_u32 s15, s32
    s_cbranch_scc1 K3_END
    s_add_u32 s33, s13, s15
    s_and_b32 s35, s12, 1
    s_lshl_b32 s34, s14, 1
    s_add_u32 s34, s34, s35
    v_lshrrev_b32 v4, 3, v0
    v_mul_u32_u24 v4, 1152, v4
    v_lshrrev_b32 v5, 4, v0
    v_and_b32 v5, 1, v5
    v_lshlrev_b32 v5, 2, v5
    v_and_b32 v6, 7, v0
    v_xor_b32 v6, v5, v6
    v_lshlrev_b32 v6, 4, v6
    v_add_u32 v3, v4, v6
    s_waitcnt lgkmcnt(0)
    s_mov_b32 s16, s6
    s_mov_b32 s17, s7
    s_mov_b32 s18, 663552
    s_mov_b32 s19, 0x00020000
    s_add_u32 s20, s10, 37804032
    s_addc_u32 s21, s11, 0
    s_mov_b32 s22, 2359296
    s_mov_b32 s23, 0x00020000
    s_add_u32 s24, s10, 26007552
    s_addc_u32 s25, s11, 0
    s_mov_b32 s26, 11796480
    s_mov_b32 s27, 0x00020000
    s_mov_b32 s28, s4
    s_mov_b32 s29, s5
    s_mov_b32 s30, 2359296
    s_mov_b32 s31, 0x00020000
    s_mov_b32 s36, s8
    s_mov_b32 s37, s9
    s_mov_b32 s38, 2359296
    s_mov_b32 s39, 0x00020000
    v_lshlrev_b32 v9, 4, v0
    s_cmp_lt_u32 s12, 4
    s_cbranch_scc0 K3_NODMA
    s_mul_i32 s15, s12, 9216
    s_lshl_b32 s40, s14, 7
    s_add_u32 s15, s15, s40
    s_lshl_b32 s40, s12, 10
    s_mov_b32 m0, s40
    s_nop 0
    buffer_load_dwordx4 v3, s[16:19], s15 offen lds
    s_add_u32 m0, m0, 4096
    s_add_u32 s15, s15, 36864
    buffer_load_dwordx4 v3, s[16:19], s15 offen lds
    s_add_u32 m0, m0, 4096
    s_add_u32 s15, s15, 36864
    buffer_load_dwordx4 v3, s[16:19], s15 offen lds
    s_add_u32 m0, m0, 4096
    s_add_u32 s15, s15, 36864
    buffer_load_dwordx4 v3, s[16:19], s15 offen lds
    s_add_u32 m0, m0, 4096
    s_add_u32 s15, s15, 36864
    buffer_load_dwordx4 v3, s[16:19], s15 offen lds
    s_add_u32 m0, m0, 4096
    s_add_u32 s15, s15, 36864
    buffer_load_dwordx4 v3, s[16:19], s15 offen lds
    s_add_u32 m0, m0, 4096
    s_add_u32 s15, s15, 36864
    buffer_load_dwordx4 v3, s[16:19], s15 offen lds
    s_add_u32 m0, m0, 4096
    s_add_u32 s15, s15, 36864
    buffer_load_dwordx4 v3, s[16:19], s15 offen lds
    s_add_u32 m0, m0, 4096
    s_add_u32 s15, s15, 36864
    buffer_load_dwordx4 v3, s[16:19], s15 offen lds
    s_add_u32 m0, m0, 4096
    s_add_u32 s15, s15, 36864
    buffer_load_dwordx4 v3, s[16:19], s15 offen lds
    s_add_u32 m0, m0, 4096
    s_add_u32 s15, s15, 36864
    buffer_load_dwordx4 v3, s[16:19], s15 offen lds
    s_add_u32 m0, m0, 4096
    s_add_u32 s15, s15, 36864
    buffer_load_dwordx4 v3, s[16:19], s15 offen lds
    s_add_u32 m0, m0, 4096
    s_add_u32 s15, s15, 36864
    buffer_load_dwordx4 v3, s[16:19], s15 offen lds
    s_add_u32 m0, m0, 4096
    s_add_u32 s15, s15, 36864
    buffer_load_dwordx4 v3, s[16:19], s15 offen lds
    s_add_u32 m0, m0, 4096
    s_add_u32 s15, s15, 36864
    buffer_load_dwordx4 v3, s[16:19], s15 offen lds
    s_add_u32 m0, m0, 4096
    s_add_u32 s15, s15, 36864
    buffer_load_dwordx4 v3, s[16:19], s15 offen lds
    s_add_u32 m0, m0, 4096
    s_add_u32 s15, s15, 36864
    buffer_load_dwordx4 v3, s[16:19], s15 offen lds
    s_add_u32 m0, m0, 4096
    s_add_u32 s15, s15, 36864
    buffer_load_dwordx4 v3, s[16:19], s15 offen lds
    s_add_u32 m0, m0, 4096
    s_add_u32 s15, s15, 36864
K3_NODMA:
    s_mul_i32 s15, s33, 36864
    s_mul_i32 s40, s35, 18432
    s_add_u32 s45, s15, s40
    buffer_load_dwordx4 v[136:139], v9, s[20:23], s45 offen offset:0
    buffer_load_dwordx4 v[140:143], v9, s[20:23], s45 offen offset:1024
    buffer_load_dwordx4 v[144:147], v9, s[20:23], s45 offen offset:2048
    buffer_load_dwordx4 v[148:151], v9, s[20:23], s45 offen offset:3072
    s_add_u32 s45, s45, 4096
    buffer_load_dwordx4 v[152:155], v9, s[20:23], s45 offen offset:0
    buffer_load_dwordx4 v[156:159], v9, s[20:23], s45 offen offset:1024
    buffer_load_dwordx4 v[160:163], v9, s[20:23], s45 offen offset:2048
    buffer_load_dwordx4 v[164:167], v9, s[20:23], s45 offen offset:3072
    s_add_u32 s45, s45, 4096
    buffer_load_dwordx4 v[168:171], v9, s[20:23], s45 offen offset:0
    buffer_load_dwordx4 v[172:175], v9, s[20:23], s45 offen offset:1024
    buffer_load_dwordx4 v[176:179], v9, s[20:23], s45 offen offset:2048
    buffer_load_dwordx4 v[180:183], v9, s[20:23], s45 offen offset:3072
    s_add_u32 s45, s45, 4096
    buffer_load_dwordx4 v[184:187], v9, s[20:23], s45 offen offset:0
    buffer_load_dwordx4 v[188:191], v9, s[20:23], s45 offen offset:1024
    buffer_load_dwordx4 v[192:195], v9, s[20:23], s45 offen offset:2048
    buffer_load_dwordx4 v[196:199], v9, s[20:23], s45 offen offset:3072
    s_add_u32 s45, s45, 4096
    buffer_load_dwordx4 v[200:203], v9, s[20:23], s45 offen offset:0
    buffer_load_dwordx4 v[204:207], v9, s[20:23], s45 offen offset:1024
    v_lshrrev_b32 v6, 5, v0
    v_lshrrev_b32 v5, 2, v0
    v_and_b32 v5, 3, v5
    v_lshlrev_b32 v7, 3, v6
    v_add_u32 v7, v7, v5
    v_lshlrev_b32 v7, 7, v7
    v_lshrrev_b32 v8, 1, v5
    v_lshlrev_b32 v8, 6, v8
    v_add_u32 v7, v7, v8
    v_lshrrev_b32 v8, 4, v0
    v_and_b32 v8, 1, v8
    v_lshlrev_b32 v8, 5, v8
    v_add_u32 v7, v7, v8
    v_and_b32 v8, 3, v0
    v_lshlrev_b32 v8, 3, v8
    v_add_u32 v7, v7, v8
    v_mov_b32 v1, v7
    v_xor_b32 v2, 64, v1
    s_mul_i32 s15, s35, 41472
    v_add_u32 v1, s15, v1
    v_add_u32 v2, s15, v2
    v_lshrrev_b32 v8, 1, v5
    v_lshl_add_u32 v11, v6, 2, v8
    v_mul_u32_u24 v11, 18, v11
    v_and_b32 v12, 1, v5
    v_add_u32 v11, v11, v12
    v_add_u32 v11, 16, v11
    v_lshlrev_b32 v11, 7, v11
    v_lshl_add_u32 v11, v8, 6, v11
    v_lshrrev_b32 v12, 4, v0
    v_and_b32 v12, 1, v12
    v_lshl_add_u32 v11, v12, 5, v11
    v_and_b32 v12, 3, v0
    v_lshl_add_u32 v209, v12, 3, v11
    v_xor_b32 v210, 64, v209
    v_and_b32 v10, 31, v0
    s_lshl_b32 s15, s33, 5
    v_add_u32 v10, s15, v10
    v_mul_u32_u24 v10, 1152, v10
    v_lshl_add_u32 v10, v6, 3, v10
    s_lshl_b32 s32, s34, 6
    s_mul_i32 s45, s33, 18
    s_add_u32 s45, s45, s34
    s_lshl_b32 s45, s45, 11
    s_waitcnt vmcnt(18)
    s_barrier
    s_cmp_eq_u32 s35, 0
    s_cbranch_scc0 K3_GEMM1
    ds_read_b64_tr_b16 v[96:97], v1 offset:0
    ds_read_b64_tr_b16 v[98:99], v1 offset:512
    ds_read_b64_tr_b16 v[100:101], v2 offset:0
    ds_read_b64_tr_b16 v[102:103], v2 offset:512
    ds_read_b64_tr_b16 v[104:105], v2 offset:2304
    ds_read_b64_tr_b16 v[106:107], v2 offset:2816
    ds_read_b64_tr_b16 v[108:109], v1 offset:2304
    ds_read_b64_tr_b16 v[110:111], v1 offset:2816
    s_waitcnt vmcnt(17) lgkmcnt(4)
    v_mfma_f32_32x32x16_bf16 v[16:31], v[96:99], v[136:139], 0
    ds_read_b64_tr_b16 v[112:113], v1 offset:4608
    ds_read_b64_tr_b16 v[114:115], v1 offset:5120
    v_mfma_f32_32x32x16_bf16 v[32:47], v[100:103], v[136:139], 0
    ds_read_b64_tr_b16 v[116:117], v2 offset:4608
    ds_read_b64_tr_b16 v[118:119], v2 offset:5120
    buffer_load_dwordx4 v[48:51], v9, s[24:27], s45 offen
    s_waitcnt vmcnt(17) lgkmcnt(4)
    v_mfma_f32_32x32x16_bf16 v[16:31], v[104:107], v[140:143], v[16:31]
    ds_read_b64_tr_b16 v[96:97], v2 offset:6912
    ds_read_b64_tr_b16 v[98:99], v2 offset:7424
    v_mfma_f32_32x32x16_bf16 v[32:47], v[108:111], v[140:143], v[32:47]
    ds_read_b64_tr_b16 v[100:101], v1 offset:6912
    ds_read_b64_tr_b16 v[102:103], v1 offset:7424
    buffer_load_dwordx4 v[52:55], v9, s[24:27], s45 offen offset:1024
    s_add_u32 s45, s45, 2359296
    s_waitcnt vmcnt(17) lgkmcnt(4)
    v_mfma_f32_32x32x16_bf16 v[16:31], v[112:115], v[144:147], v[16:31]
    ds_read_b64_tr_b16 v[104:105], v1 offset:9216
    ds_read_b64_tr_b16 v[106:107], v1 offset:9728
    v_mfma_f32_32x32x16_bf16 v[32:47], v[116:119], v[144:147], v[32:47]
    ds_read_b64_tr_b16 v[108:109], v2 offset:9216
    ds_read_b64_tr_b16 v[110:111], v2 offset:9728
    buffer_load_dwordx4 v[56:59], v9, s[24:27], s45 offen
    s_waitcnt vmcnt(17) lgkmcnt(4)
    v_mfma_f32_32x32x16_bf16 v[16:31], v[96:99], v[148:151], v[16:31]
    ds_read_b64_tr_b16 v[112:113], v2 offset:11520
    ds_read_b64_tr_b16 v[114:115], v2 offset:12032
    v_mfma_f32_32x32x16_bf16 v[32:47], v[100:103], v[148:151], v[32:47]
    ds_read_b64_tr_b16 v[116:117], v1 offset:11520
    ds_read_b64_tr_b16 v[118:119], v1 offset:12032
    buffer_load_dwordx4 v[60:63], v9, s[24:27], s45 offen offset:1024
    s_add_u32 s45, s45, 2359296
    s_waitcnt vmcnt(17) lgkmcnt(4)
    v_mfma_f32_32x32x16_bf16 v[16:31], v[104:107], v[152:155], v[16:31]
    ds_read_b64_tr_b16 v[96:97], v1 offset:13824
    ds_read_b64_tr_b16 v[98:99], v1 offset:14336
    v_mfma_f32_32x32x16_bf16 v[32:47], v[108:111], v[152:155], v[32:47]
    ds_read_b64_tr_b16 v[100:101], v2 offset:13824
    ds_read_b64_tr_b16 v[102:103], v2 offset:14336
    buffer_load_dwordx4 v[64:67], v9, s[24:27], s45 offen
    s_waitcnt vmcnt(17) lgkmcnt(4)
    v_mfma_f32_32x32x16_bf16 v[16:31], v[112:115], v[156:159], v[16:31]
    ds_read_b64_tr_b16 v[104:105], v2 offset:16128
    ds_read_b64_tr_b16 v[106:107], v2 offset:16640
    v_mfma_f32_32x32x16_bf16 v[32:47], v[116:119], v[156:159], v[32:47]
    ds_read_b64_tr_b16 v[108:109], v1 offset:16128
    ds_read_b64_tr_b16 v[110:111], v1 offset:16640
    buffer_load_dwordx4 v[68:71], v9, s[24:27], s45 offen offset:1024
    s_add_u32 s45, s45, 2359296
    s_waitcnt vmcnt(17) lgkmcnt(4)
    v_mfma_f32_32x32x16_bf16 v[16:31], v[96:99], v[160:163], v[16:31]
    ds_read_b64_tr_b16 v[112:113], v1 offset:18432
    ds_read_b64_tr_b16 v[114:115], v1 offset:18944
    v_mfma_f32_32x32x16_bf16 v[32:47], v[100:103], v[160:163], v[32:47]
    ds_read_b64_tr_b16 v[116:117], v2 offset:18432
    ds_read_b64_tr_b16 v[118:119], v2 offset:18944
    buffer_load_dwordx4 v[72:75], v9, s[24:27], s45 offen
    s_waitcnt vmcnt(17) lgkmcnt(4)
    v_mfma_f32_32x32x16_bf16 v[16:31], v[104:107], v[164:167], v[16:31]
    ds_read_b64_tr_b16 v[96:97], v2 offset:20736
    ds_read_b64_tr_b16 v[98:99], v2 offset:21248
    v_mfma_f32_32x32x16_bf16 v[32:47], v[108:111], v[164:167], v[32:47]
    ds_read_b64_tr_b16 v[100:101], v1 offset:20736
    ds_read_b64_tr_b16 v[102:103], v1 offset:21248
    buffer_load_dwordx4 v[76:79], v9, s[24:27], s45 offen offset:1024
    s_add_u32 s45, s45, 2359296
    s_waitcnt vmcnt(17) lgkmcnt(4)
    v_mfma_f32_32x32x16_bf16 v[16:31], v[112:115], v[168:171], v[16:31]
    ds_read_b64_tr_b16 v[104:105], v1 offset:23040
    ds_read_b64_tr_b16 v[106:107], v1 offset:23552
    v_mfma_f32_32x32x16_bf16 v[32:47], v[116:119], v[168:171], v[32:47]
    ds_read_b64_tr_b16 v[108:109], v2 offset:23040
    ds_read_b64_tr_b16 v[110:111], v2 offset:23552
    buffer_load_dwordx4 v[80:83], v9, s[24:27], s45 offen
    s_waitcnt vmcnt(17) lgkmcnt(4)
    v_mfma_f32_32x32x16_bf16 v[16:31], v[96:99], v[172:175], v[16:31]
    ds_read_b64_tr_b16 v[112:113], v2 offset:25344
    ds_read_b64_tr_b16 v[114:115], v2 offset:25856
    v_mfma_f32_32x32x16_bf16 v[32:47], v[100:103], v[172:175], v[32:47]
    ds_read_b64_tr_b16 v[116:117], v1 offset:25344
    ds_read_b64_tr_b16 v[118:119], v1 offset:25856
    buffer_load_dwordx4 v[84:87], v9, s[24:27], s45 offen offset:1024
    s_add_u32 s45, s45, 2359296
    s_waitcnt vmcnt(17) lgkmcnt(4)
    v_mfma_f32_32x32x16_bf16 v[16:31], v[104:107], v[176:179], v[16:31]
    ds_read_b64_tr_b16 v[96:97], v1 offset:27648
    ds_read_b64_tr_b16 v[98:99], v1 offset:28160
    v_mfma_f32_32x32x16_bf16 v[32:47], v[108:111], v[176:179], v[32:47]
    ds_read_b64_tr_b16 v[100:101], v2 offset:27648
    ds_read_b64_tr_b16 v[102:103], v2 offset:28160
    buffer_load_dwordx2 v[88:89], v10, s[28:31], s32 offen offset:0
    s_waitcnt vmcnt(17) lgkmcnt(4)
    v_mfma_f32_32x32x16_bf16 v[16:31], v[112:115], v[180:183], v[16:31]
    ds_read_b64_tr_b16 v[104:105], v2 offset:29952
    ds_read_b64_tr_b16 v[106:107], v2 offset:30464
    v_mfma_f32_32x32x16_bf16 v[32:47], v[116:119], v[180:183], v[32:47]
    ds_read_b64_tr_b16 v[108:109], v1 offset:29952
    ds_read_b64_tr_b16 v[110:111], v1 offset:30464
    buffer_load_dwordx2 v[90:91], v10, s[28:31], s32 offen offset:16
    s_waitcnt vmcnt(17) lgkmcnt(4)
    v_mfma_f32_32x32x16_bf16 v[16:31], v[96:99], v[184:187], v[16:31]
    ds_read_b64_tr_b16 v[112:113], v1 offset:32256
    ds_read_b64_tr_b16 v[114:115], v1 offset:32768
    v_mfma_f32_32x32x16_bf16 v[32:47], v[100:103], v[184:187], v[32:47]
    ds_read_b64_tr_b16 v[116:117], v2 offset:32256
    ds_read_b64_tr_b16 v[118:119], v2 offset:32768
    buffer_load_dwordx2 v[92:93], v10, s[28:31], s32 offen offset:32
    s_waitcnt vmcnt(17) lgkmcnt(4)
    v_mfma_f32_32x32x16_bf16 v[16:31], v[104:107], v[188:191], v[16:31]
    ds_read_b64_tr_b16 v[96:97], v2 offset:34560
    ds_read_b64_tr_b16 v[98:99], v2 offset:35072
    v_mfma_f32_32x32x16_bf16 v[32:47], v[108:111], v[188:191], v[32:47]
    ds_read_b64_tr_b16 v[100:101], v1 offset:34560
    ds_read_b64_tr_b16 v[102:103], v1 offset:35072
    buffer_load_dwordx2 v[94:95], v10, s[28:31], s32 offen offset:48
    s_waitcnt vmcnt(17) lgkmcnt(4)
    v_mfma_f32_32x32x16_bf16 v[16:31], v[112:115], v[192:195], v[16:31]
    ds_read_b64_tr_b16 v[104:105], v1 offset:36864
    ds_read_b64_tr_b16 v[106:107], v1 offset:37376
    v_mfma_f32_32x32x16_bf16 v[32:47], v[116:119], v[192:195], v[32:47]
    ds_read_b64_tr_b16 v[108:109], v2 offset:36864
    ds_read_b64_tr_b16 v[110:111], v2 offset:37376
    s_waitcnt vmcnt(16) lgkmcnt(4)
    v_mfma_f32_32x32x16_bf16 v[16:31], v[96:99], v[196:199], v[16:31]
    ds_read_b64_tr_b16 v[112:113], v2 offset:39168
    ds_read_b64_tr_b16 v[114:115], v2 offset:39680
    v_mfma_f32_32x32x16_bf16 v[32:47], v[100:103], v[196:199], v[32:47]
    ds_read_b64_tr_b16 v[116:117], v1 offset:39168
    ds_read_b64_tr_b16 v[118:119], v1 offset:39680
    s_waitcnt vmcnt(15) lgkmcnt(4)
    v_mfma_f32_32x32x16_bf16 v[16:31], v[104:107], v[200:203], v[16:31]
    v_mfma_f32_32x32x16_bf16 v[32:47], v[108:111], v[200:203], v[32:47]
    s_waitcnt vmcnt(14) lgkmcnt(0)
    v_mfma_f32_32x32x16_bf16 v[16:31], v[112:115], v[204:207], v[16:31]
    v_mfma_f32_32x32x16_bf16 v[32:47], v[116:119], v[204:207], v[32:47]
    s_branch K3_GEMMD
K3_GEMM1:
    ds_read_b64_tr_b16 v[96:97], v1 offset:0
    ds_read_b64_tr_b16 v[98:99], v1 offset:512
    ds_read_b64_tr_b16 v[100:101], v2 offset:0
    ds_read_b64_tr_b16 v[102:103], v2 offset:512
    ds_read_b64_tr_b16 v[104:105], v2 offset:2304
    ds_read_b64_tr_b16 v[106:107], v2 offset:2816
    ds_read_b64_tr_b16 v[108:109], v1 offset:2304
    ds_read_b64_tr_b16 v[110:111], v1 offset:2816
    s_waitcnt vmcnt(17) lgkmcnt(4)
    v_mfma_f32_32x32x16_bf16 v[16:31], v[96:99], v[136:139], 0
    ds_read_b64_tr_b16 v[112:113], v1 offset:4608
    ds_read_b64_tr_b16 v[114:115], v1 offset:5120
    v_mfma_f32_32x32x16_bf16 v[32:47], v[100:103], v[136:139], 0
    ds_read_b64_tr_b16 v[116:117], v2 offset:4608
    ds_read_b64_tr_b16 v[118:119], v2 offset:5120
    buffer_load_dwordx4 v[48:51], v9, s[24:27], s45 offen
    s_waitcnt vmcnt(17) lgkmcnt(4)
    v_mfma_f32_32x32x16_bf16 v[16:31], v[104:107], v[140:143], v[16:31]
    ds_read_b64_tr_b16 v[96:97], v2 offset:6912
    ds_read_b64_tr_b16 v[98:99], v2 offset:7424
    v_mfma_f32_32x32x16_bf16 v[32:47], v[108:111], v[140:143], v[32:47]
    ds_read_b64_tr_b16 v[100:101], v1 offset:6912
    ds_read_b64_tr_b16 v[102:103], v1 offset:7424
    buffer_load_dwordx4 v[52:55], v9, s[24:27], s45 offen offset:1024
    s_add_u32 s45, s45, 2359296
    s_waitcnt vmcnt(17) lgkmcnt(4)
    v_mfma_f32_32x32x16_bf16 v[16:31], v[112:115], v[144:147], v[16:31]
    ds_read_b64_tr_b16 v[104:105], v1 offset:9216
    ds_read_b64_tr_b16 v[106:107], v1 offset:9728
    v_mfma_f32_32x32x16_bf16 v[32:47], v[116:119], v[144:147], v[32:47]
    ds_read_b64_tr_b16 v[108:109], v2 offset:9216
    ds_read_b64_tr_b16 v[110:111], v2 offset:9728
    buffer_load_dwordx4 v[56:59], v9, s[24:27], s45 offen
    s_waitcnt vmcnt(17) lgkmcnt(4)
    v_mfma_f32_32x32x16_bf16 v[16:31], v[96:99], v[148:151], v[16:31]
    ds_read_b64_tr_b16 v[112:113], v2 offset:11520
    ds_read_b64_tr_b16 v[114:115], v2 offset:12032
    v_mfma_f32_32x32x16_bf16 v[32:47], v[100:103], v[148:151], v[32:47]
    ds_read_b64_tr_b16 v[116:117], v1 offset:11520
    ds_read_b64_tr_b16 v[118:119], v1 offset:12032
    buffer_load_dwordx4 v[60:63], v9, s[24:27], s45 offen offset:1024
    s_add_u32 s45, s45, 2359296
    s_waitcnt vmcnt(17) lgkmcnt(4)
    v_mfma_f32_32x32x16_bf16 v[16:31], v[104:107], v[152:155], v[16:31]
    ds_read_b64_tr_b16 v[96:97], v1 offset:13824
    ds_read_b64_tr_b16 v[98:99], v1 offset:14336
    v_mfma_f32_32x32x16_bf16 v[32:47], v[108:111], v[152:155], v[32:47]
    ds_read_b64_tr_b16 v[100:101], v2 offset:13824
    ds_read_b64_tr_b16 v[102:103], v2 offset:14336
    buffer_load_dwordx4 v[64:67], v9, s[24:27], s45 offen
    s_waitcnt vmcnt(17) lgkmcnt(4)
    v_mfma_f32_32x32x16_bf16 v[16:31], v[112:115], v[156:159], v[16:31]
    ds_read_b64_tr_b16 v[104:105], v2 offset:16128
    ds_read_b64_tr_b16 v[106:107], v2 offset:16640
    v_mfma_f32_32x32x16_bf16 v[32:47], v[116:119], v[156:159], v[32:47]
    ds_read_b64_tr_b16 v[108:109], v1 offset:16128
    ds_read_b64_tr_b16 v[110:111], v1 offset:16640
    buffer_load_dwordx4 v[68:71], v9, s[24:27], s45 offen offset:1024
    s_add_u32 s45, s45, 2359296
    s_waitcnt vmcnt(17) lgkmcnt(4)
    v_mfma_f32_32x32x16_bf16 v[16:31], v[96:99], v[160:163], v[16:31]
    ds_read_b64_tr_b16 v[112:113], v1 offset:18432
    ds_read_b64_tr_b16 v[114:115], v1 offset:18944
    v_mfma_f32_32x32x16_bf16 v[32:47], v[100:103], v[160:163], v[32:47]
    ds_read_b64_tr_b16 v[116:117], v2 offset:18432
    ds_read_b64_tr_b16 v[118:119], v2 offset:18944
    buffer_load_dwordx4 v[72:75], v9, s[24:27], s45 offen
    s_waitcnt vmcnt(17) lgkmcnt(4)
    v_mfma_f32_32x32x16_bf16 v[16:31], v[104:107], v[164:167], v[16:31]
    ds_read_b64_tr_b16 v[96:97], v2 offset:20736
    ds_read_b64_tr_b16 v[98:99], v2 offset:21248
    v_mfma_f32_32x32x16_bf16 v[32:47], v[108:111], v[164:167], v[32:47]
    ds_read_b64_tr_b16 v[100:101], v1 offset:20736
    ds_read_b64_tr_b16 v[102:103], v1 offset:21248
    buffer_load_dwordx4 v[76:79], v9, s[24:27], s45 offen offset:1024
    s_add_u32 s45, s45, 2359296
    s_waitcnt vmcnt(17) lgkmcnt(4)
    v_mfma_f32_32x32x16_bf16 v[16:31], v[112:115], v[168:171], v[16:31]
    ds_read_b64_tr_b16 v[104:105], v1 offset:23040
    ds_read_b64_tr_b16 v[106:107], v1 offset:23552
    v_mfma_f32_32x32x16_bf16 v[32:47], v[116:119], v[168:171], v[32:47]
    ds_read_b64_tr_b16 v[108:109], v2 offset:23040
    ds_read_b64_tr_b16 v[110:111], v2 offset:23552
    buffer_load_dwordx4 v[80:83], v9, s[24:27], s45 offen
    s_waitcnt vmcnt(17) lgkmcnt(4)
    v_mfma_f32_32x32x16_bf16 v[16:31], v[96:99], v[172:175], v[16:31]
    ds_read_b64_tr_b16 v[112:113], v2 offset:25344
    ds_read_b64_tr_b16 v[114:115], v2 offset:25856
    v_mfma_f32_32x32x16_bf16 v[32:47], v[100:103], v[172:175], v[32:47]
    ds_read_b64_tr_b16 v[116:117], v1 offset:25344
    ds_read_b64_tr_b16 v[118:119], v1 offset:25856
    buffer_load_dwordx4 v[84:87], v9, s[24:27], s45 offen offset:1024
    s_add_u32 s45, s45, 2359296
    s_waitcnt vmcnt(17) lgkmcnt(4)
    v_mfma_f32_32x32x16_bf16 v[16:31], v[104:107], v[176:179], v[16:31]
    ds_read_b64_tr_b16 v[96:97], v1 offset:27648
    ds_read_b64_tr_b16 v[98:99], v1 offset:28160
    v_mfma_f32_32x32x16_bf16 v[32:47], v[108:111], v[176:179], v[32:47]
    ds_read_b64_tr_b16 v[100:101], v2 offset:27648
    ds_read_b64_tr_b16 v[102:103], v2 offset:28160
    buffer_load_dwordx2 v[88:89], v10, s[28:31], s32 offen offset:0
    s_waitcnt vmcnt(17) lgkmcnt(4)
    v_mfma_f32_32x32x16_bf16 v[16:31], v[112:115], v[180:183], v[16:31]
    ds_read_b64_tr_b16 v[104:105], v2 offset:29952
    ds_read_b64_tr_b16 v[106:107], v2 offset:30464
    v_mfma_f32_32x32x16_bf16 v[32:47], v[116:119], v[180:183], v[32:47]
    ds_read_b64_tr_b16 v[108:109], v1 offset:29952
    ds_read_b64_tr_b16 v[110:111], v1 offset:30464
    buffer_load_dwordx2 v[90:91], v10, s[28:31], s32 offen offset:16
    s_waitcnt vmcnt(17) lgkmcnt(4)
    v_mfma_f32_32x32x16_bf16 v[16:31], v[96:99], v[184:187], v[16:31]
    ds_read_b64_tr_b16 v[112:113], v209 offset:0
    ds_read_b64_tr_b16 v[114:115], v209 offset:4608
    v_mfma_f32_32x32x16_bf16 v[32:47], v[100:103], v[184:187], v[32:47]
    ds_read_b64_tr_b16 v[116:117], v210 offset:0
    ds_read_b64_tr_b16 v[118:119], v210 offset:4608
    buffer_load_dwordx2 v[92:93], v10, s[28:31], s32 offen offset:32
    s_waitcnt vmcnt(17) lgkmcnt(4)
    v_mfma_f32_32x32x16_bf16 v[16:31], v[104:107], v[188:191], v[16:31]
    ds_read_b64_tr_b16 v[96:97], v209 offset:18432
    ds_read_b64_tr_b16 v[98:99], v209 offset:23040
    v_mfma_f32_32x32x16_bf16 v[32:47], v[108:111], v[188:191], v[32:47]
    ds_read_b64_tr_b16 v[100:101], v210 offset:18432
    ds_read_b64_tr_b16 v[102:103], v210 offset:23040
    buffer_load_dwordx2 v[94:95], v10, s[28:31], s32 offen offset:48
    s_waitcnt vmcnt(17) lgkmcnt(4)
    v_mfma_f32_32x32x16_bf16 v[16:31], v[112:115], v[192:195], v[16:31]
    ds_read_b64_tr_b16 v[104:105], v209 offset:36864
    ds_read_b64_tr_b16 v[106:107], v209 offset:41472
    v_mfma_f32_32x32x16_bf16 v[32:47], v[116:119], v[192:195], v[32:47]
    ds_read_b64_tr_b16 v[108:109], v210 offset:36864
    ds_read_b64_tr_b16 v[110:111], v210 offset:41472
    s_waitcnt vmcnt(16) lgkmcnt(4)
    v_mfma_f32_32x32x16_bf16 v[16:31], v[96:99], v[196:199], v[16:31]
    ds_read_b64_tr_b16 v[112:113], v209 offset:55296
    ds_read_b64_tr_b16 v[114:115], v209 offset:59904
    v_mfma_f32_32x32x16_bf16 v[32:47], v[100:103], v[196:199], v[32:47]
    ds_read_b64_tr_b16 v[116:117], v210 offset:55296
    ds_read_b64_tr_b16 v[118:119], v210 offset:59904
    s_waitcnt vmcnt(15) lgkmcnt(4)
    v_mfma_f32_32x32x16_bf16 v[16:31], v[104:107], v[200:203], v[16:31]
    v_mfma_f32_32x32x16_bf16 v[32:47], v[108:111], v[200:203], v[32:47]
    s_waitcnt vmcnt(14) lgkmcnt(0)
    v_mfma_f32_32x32x16_bf16 v[16:31], v[112:115], v[204:207], v[16:31]
    v_mfma_f32_32x32x16_bf16 v[32:47], v[116:119], v[204:207], v[32:47]
K3_GEMMD:
    s_barrier
    v_lshlrev_b32 v4, 4, v0
    s_lshl_b32 s15, s12, 12
    v_add_u32 v5, s15, v4
    s_xor_b32 s15, s12, 1
    s_lshl_b32 s15, s15, 12
    v_add_u32 v7, s15, v4
    s_cmp_eq_u32 s35, 0
    s_nop 7
    s_cbranch_scc0 K3_HI
    ds_write_b128 v5, v[32:35] offset:0
    ds_write_b128 v5, v[36:39] offset:1024
    ds_write_b128 v5, v[40:43] offset:2048
    ds_write_b128 v5, v[44:47] offset:3072
    s_branch K3_SENT
K3_HI:
    ds_write_b128 v5, v[16:19] offset:0
    ds_write_b128 v5, v[20:23] offset:1024
    ds_write_b128 v5, v[24:27] offset:2048
    ds_write_b128 v5, v[28:31] offset:3072
    s_waitcnt lgkmcnt(0)
    v_mov_b32 v16, v32
    v_mov_b32 v17, v33
    v_mov_b32 v18, v34
    v_mov_b32 v19, v35
    v_mov_b32 v20, v36
    v_mov_b32 v21, v37
    v_mov_b32 v22, v38
    v_mov_b32 v23, v39
    v_mov_b32 v24, v40
    v_mov_b32 v25, v41
    v_mov_b32 v26, v42
    v_mov_b32 v27, v43
    v_mov_b32 v28, v44
    v_mov_b32 v29, v45
    v_mov_b32 v30, v46
    v_mov_b32 v31, v47
K3_SENT:
    s_waitcnt lgkmcnt(0)
    s_barrier
    ds_read_b128 v[32:35], v7 offset:0
    ds_read_b128 v[36:39], v7 offset:1024
    ds_read_b128 v[40:43], v7 offset:2048
    ds_read_b128 v[44:47], v7 offset:3072
    v_mov_b32 v4, 0x00003f80
    v_mov_b32 v5, 0x3f800000
    v_mov_b32 v120, 0
    v_mov_b32 v121, 0
    v_mov_b32 v122, 0
    v_mov_b32 v123, 0
    v_mov_b32 v124, 0
    v_mov_b32 v125, 0
    v_mov_b32 v126, 0
    v_mov_b32 v127, 0
    v_mov_b32 v128, 0
    v_mov_b32 v129, 0
    v_mov_b32 v130, 0
    v_mov_b32 v131, 0
    v_mov_b32 v132, 0
    v_mov_b32 v133, 0
    v_mov_b32 v134, 0
    v_mov_b32 v135, 0
    s_waitcnt vmcnt(12)
    v_dot2_f32_bf16 v120, v48, v4, v120
    v_dot2_f32_bf16 v121, v48, v5, v121
    v_dot2_f32_bf16 v122, v49, v4, v122
    v_dot2_f32_bf16 v123, v49, v5, v123
    v_dot2_f32_bf16 v124, v50, v4, v124
    v_dot2_f32_bf16 v125, v50, v5, v125
    v_dot2_f32_bf16 v126, v51, v4, v126
    v_dot2_f32_bf16 v127, v51, v5, v127
    v_dot2_f32_bf16 v128, v52, v4, v128
    v_dot2_f32_bf16 v129, v52, v5, v129
    v_dot2_f32_bf16 v130, v53, v4, v130
    v_dot2_f32_bf16 v131, v53, v5, v131
    v_dot2_f32_bf16 v132, v54, v4, v132
    v_dot2_f32_bf16 v133, v54, v5, v133
    v_dot2_f32_bf16 v134, v55, v4, v134
    v_dot2_f32_bf16 v135, v55, v5, v135
    s_waitcnt vmcnt(10)
    v_dot2_f32_bf16 v120, v56, v4, v120
    v_dot2_f32_bf16 v121, v56, v5, v121
    v_dot2_f32_bf16 v122, v57, v4, v122
    v_dot2_f32_bf16 v123, v57, v5, v123
    v_dot2_f32_bf16 v124, v58, v4, v124
    v_dot2_f32_bf16 v125, v58, v5, v125
    v_dot2_f32_bf16 v126, v59, v4, v126
    v_dot2_f32_bf16 v127, v59, v5, v127
    v_dot2_f32_bf16 v128, v60, v4, v128
    v_dot2_f32_bf16 v129, v60, v5, v129
    v_dot2_f32_bf16 v130, v61, v4, v130
    v_dot2_f32_bf16 v131, v61, v5, v131
    v_dot2_f32_bf16 v132, v62, v4, v132
    v_dot2_f32_bf16 v133, v62, v5, v133
    v_dot2_f32_bf16 v134, v63, v4, v134
    v_dot2_f32_bf16 v135, v63, v5, v135
    s_waitcnt vmcnt(8)
    v_dot2_f32_bf16 v120, v64, v4, v120
    v_dot2_f32_bf16 v121, v64, v5, v121
    v_dot2_f32_bf16 v122, v65, v4, v122
    v_dot2_f32_bf16 v123, v65, v5, v123
    v_dot2_f32_bf16 v124, v66, v4, v124
    v_dot2_f32_bf16 v125, v66, v5, v125
    v_dot2_f32_bf16 v126, v67, v4, v126
    v_dot2_f32_bf16 v127, v67, v5, v127
    v_dot2_f32_bf16 v128, v68, v4, v128
    v_dot2_f32_bf16 v129, v68, v5, v129
    v_dot2_f32_bf16 v130, v69, v4, v130
    v_dot2_f32_bf16 v131, v69, v5, v131
    v_dot2_f32_bf16 v132, v70, v4, v132
    v_dot2_f32_bf16 v133, v70, v5, v133
    v_dot2_f32_bf16 v134, v71, v4, v134
    v_dot2_f32_bf16 v135, v71, v5, v135
    s_waitcnt vmcnt(6)
    v_dot2_f32_bf16 v120, v72, v4, v120
    v_dot2_f32_bf16 v121, v72, v5, v121
    v_dot2_f32_bf16 v122, v73, v4, v122
    v_dot2_f32_bf16 v123, v73, v5, v123
    v_dot2_f32_bf16 v124, v74, v4, v124
    v_dot2_f32_bf16 v125, v74, v5, v125
    v_dot2_f32_bf16 v126, v75, v4, v126
    v_dot2_f32_bf16 v127, v75, v5, v127
    v_dot2_f32_bf16 v128, v76, v4, v128
    v_dot2_f32_bf16 v129, v76, v5, v129
    v_dot2_f32_bf16 v130, v77, v4, v130
    v_dot2_f32_bf16 v131, v77, v5, v131
    v_dot2_f32_bf16 v132, v78, v4, v132
    v_dot2_f32_bf16 v133, v78, v5, v133
    v_dot2_f32_bf16 v134, v79, v4, v134
    v_dot2_f32_bf16 v135, v79, v5, v135
    s_waitcnt vmcnt(4)
    v_dot2_f32_bf16 v120, v80, v4, v120
    v_dot2_f32_bf16 v121, v80, v5, v121
    v_dot2_f32_bf16 v122, v81, v4, v122
    v_dot2_f32_bf16 v123, v81, v5, v123
    v_dot2_f32_bf16 v124, v82, v4, v124
    v_dot2_f32_bf16 v125, v82, v5, v125
    v_dot2_f32_bf16 v126, v83, v4, v126
    v_dot2_f32_bf16 v127, v83, v5, v127
    v_dot2_f32_bf16 v128, v84, v4, v128
    v_dot2_f32_bf16 v129, v84, v5, v129
    v_dot2_f32_bf16 v130, v85, v4, v130
    v_dot2_f32_bf16 v131, v85, v5, v131
    v_dot2_f32_bf16 v132, v86, v4, v132
    v_dot2_f32_bf16 v133, v86, v5, v133
    v_dot2_f32_bf16 v134, v87, v4, v134
    v_dot2_f32_bf16 v135, v87, v5, v135
    s_waitcnt lgkmcnt(0)
    v_add_f32 v16, v16, v32
    v_add_f32 v17, v17, v33
    v_add_f32 v18, v18, v34
    v_add_f32 v19, v19, v35
    v_add_f32 v20, v20, v36
    v_add_f32 v21, v21, v37
    v_add_f32 v22, v22, v38
    v_add_f32 v23, v23, v39
    v_add_f32 v24, v24, v40
    v_add_f32 v25, v25, v41
    v_add_f32 v26, v26, v42
    v_add_f32 v27, v27, v43
    v_add_f32 v28, v28, v44
    v_add_f32 v29, v29, v45
    v_add_f32 v30, v30, v46
    v_add_f32 v31, v31, v47
    v_mul_f32 v48, 0xbfb8aa3b, v120
    v_mul_f32 v49, 0xbfb8aa3b, v121
    v_mul_f32 v50, 0xbfb8aa3b, v122
    v_mul_f32 v51, 0xbfb8aa3b, v123
    v_mul_f32 v52, 0xbfb8aa3b, v124
    v_mul_f32 v53, 0xbfb8aa3b, v125
    v_mul_f32 v54, 0xbfb8aa3b, v126
    v_mul_f32 v55, 0xbfb8aa3b, v127
    v_mul_f32 v56, 0xbfb8aa3b, v128
    v_mul_f32 v57, 0xbfb8aa3b, v129
    v_mul_f32 v58, 0xbfb8aa3b, v130
    v_mul_f32 v59, 0xbfb8aa3b, v131
    v_mul_f32 v60, 0xbfb8aa3b, v132
    v_mul_f32 v61, 0xbfb8aa3b, v133
    v_mul_f32 v62, 0xbfb8aa3b, v134
    v_mul_f32 v63, 0xbfb8aa3b, v135
    v_exp_f32 v48, v48
    v_exp_f32 v49, v49
    v_exp_f32 v50, v50
    v_exp_f32 v51, v51
    v_exp_f32 v52, v52
    v_exp_f32 v53, v53
    v_exp_f32 v54, v54
    v_exp_f32 v55, v55
    v_exp_f32 v56, v56
    v_exp_f32 v57, v57
    v_exp_f32 v58, v58
    v_exp_f32 v59, v59
    v_exp_f32 v60, v60
    v_exp_f32 v61, v61
    v_exp_f32 v62, v62
    v_exp_f32 v63, v63
    v_add_f32 v48, 1.0, v48
    v_add_f32 v49, 1.0, v49
    v_add_f32 v50, 1.0, v50
    v_add_f32 v51, 1.0, v51
    v_add_f32 v52, 1.0, v52
    v_add_f32 v53, 1.0, v53
    v_add_f32 v54, 1.0, v54
    v_add_f32 v55, 1.0, v55
    v_add_f32 v56, 1.0, v56
    v_add_f32 v57, 1.0, v57
    v_add_f32 v58, 1.0, v58
    v_add_f32 v59, 1.0, v59
    v_add_f32 v60, 1.0, v60
    v_add_f32 v61, 1.0, v61
    v_add_f32 v62, 1.0, v62
    v_add_f32 v63, 1.0, v63
    v_rcp_f32 v48, v48
    v_rcp_f32 v49, v49
    v_rcp_f32 v50, v50
    v_rcp_f32 v51, v51
    v_rcp_f32 v52, v52
    v_rcp_f32 v53, v53
    v_rcp_f32 v54, v54
    v_rcp_f32 v55, v55
    v_rcp_f32 v56, v56
    v_rcp_f32 v57, v57
    v_rcp_f32 v58, v58
    v_rcp_f32 v59, v59
    v_rcp_f32 v60, v60
    v_rcp_f32 v61, v61
    v_rcp_f32 v62, v62
    v_rcp_f32 v63, v63
    v_mul_f32 v48, v48, v120
    v_mul_f32 v49, v49, v121
    v_mul_f32 v50, v50, v122
    v_mul_f32 v51, v51, v123
    v_mul_f32 v52, v52, v124
    v_mul_f32 v53, v53, v125
    v_mul_f32 v54, v54, v126
    v_mul_f32 v55, v55, v127
    v_mul_f32 v56, v56, v128
    v_mul_f32 v57, v57, v129
    v_mul_f32 v58, v58, v130
    v_mul_f32 v59, v59, v131
    v_mul_f32 v60, v60, v132
    v_mul_f32 v61, v61, v133
    v_mul_f32 v62, v62, v134
    v_mul_f32 v63, v63, v135
    s_waitcnt vmcnt(0)
    v_lshlrev_b32 v64, 16, v88
    v_and_b32 v65, 0xffff0000, v88
    v_lshlrev_b32 v66, 16, v89
    v_and_b32 v67, 0xffff0000, v89
    v_lshlrev_b32 v68, 16, v90
    v_and_b32 v69, 0xffff0000, v90
    v_lshlrev_b32 v70, 16, v91
    v_and_b32 v71, 0xffff0000, v91
    v_lshlrev_b32 v72, 16, v92
    v_and_b32 v73, 0xffff0000, v92
    v_lshlrev_b32 v74, 16, v93
    v_and_b32 v75, 0xffff0000, v93
    v_lshlrev_b32 v76, 16, v94
    v_and_b32 v77, 0xffff0000, v94
    v_lshlrev_b32 v78, 16, v95
    v_and_b32 v79, 0xffff0000, v95
    v_fma_f32 v64, v16, v48, v64
    v_fma_f32 v65, v17, v49, v65
    v_fma_f32 v66, v18, v50, v66
    v_fma_f32 v67, v19, v51, v67
    v_fma_f32 v68, v20, v52, v68
    v_fma_f32 v69, v21, v53, v69
    v_fma_f32 v70, v22, v54, v70
    v_fma_f32 v71, v23, v55, v71
    v_fma_f32 v72, v24, v56, v72
    v_fma_f32 v73, v25, v57, v73
    v_fma_f32 v74, v26, v58, v74
    v_fma_f32 v75, v27, v59, v75
    v_fma_f32 v76, v28, v60, v76
    v_fma_f32 v77, v29, v61, v77
    v_fma_f32 v78, v30, v62, v78
    v_fma_f32 v79, v31, v63, v79
    v_cvt_pk_bf16_f32 v88, v64, v65
    v_cvt_pk_bf16_f32 v89, v66, v67
    v_cvt_pk_bf16_f32 v90, v68, v69
    v_cvt_pk_bf16_f32 v91, v70, v71
    v_cvt_pk_bf16_f32 v92, v72, v73
    v_cvt_pk_bf16_f32 v93, v74, v75
    v_cvt_pk_bf16_f32 v94, v76, v77
    v_cvt_pk_bf16_f32 v95, v78, v79
    buffer_store_dwordx2 v[88:89], v10, s[36:39], s32 offen offset:0
    buffer_store_dwordx2 v[90:91], v10, s[36:39], s32 offen offset:16
    buffer_store_dwordx2 v[92:93], v10, s[36:39], s32 offen offset:32
    buffer_store_dwordx2 v[94:95], v10, s[36:39], s32 offen offset:48
K3_END:
    s_endpgm
K3_CODE_END:
.section .rodata,"a"
.p2align 6
.amdhsa_kernel k1_proj_kernel
  .amdhsa_next_free_vgpr 352
  .amdhsa_next_free_sgpr 64
  .amdhsa_accum_offset 256
  .amdhsa_group_segment_fixed_size 0
  .amdhsa_kernarg_size 80
  .amdhsa_user_sgpr_count 2
  .amdhsa_user_sgpr_kernarg_segment_ptr 1
  .amdhsa_system_sgpr_workgroup_id_x 1
  .amdhsa_float_denorm_mode_32 3
.end_amdhsa_kernel
.p2align 6
.amdhsa_kernel k2_attn_kernel
  .amdhsa_next_free_vgpr 176
  .amdhsa_next_free_sgpr 64
  .amdhsa_accum_offset 176
  .amdhsa_group_segment_fixed_size 0
  .amdhsa_kernarg_size 80
  .amdhsa_user_sgpr_count 2
  .amdhsa_user_sgpr_kernarg_segment_ptr 1
  .amdhsa_system_sgpr_workgroup_id_x 1
  .amdhsa_float_denorm_mode_32 0
.end_amdhsa_kernel
.p2align 6
.amdhsa_kernel k3_out_kernel
  .amdhsa_next_free_vgpr 216
  .amdhsa_next_free_sgpr 64
  .amdhsa_accum_offset 216
  .amdhsa_group_segment_fixed_size 0
  .amdhsa_kernarg_size 80
  .amdhsa_user_sgpr_count 2
  .amdhsa_user_sgpr_kernarg_segment_ptr 1
  .amdhsa_system_sgpr_workgroup_id_x 1
  .amdhsa_float_denorm_mode_32 3
.end_amdhsa_kernel
```
